```python
import torch

def _softmax(x, axis=-1):
    return torch.softmax(x, dim=axis)
def _gelu(x):
    return torch.nn.functional.gelu(x, approximate="tanh")
def _silu(x):
    return torch.nn.functional.silu(x)
def _sigmoid(x):
    return torch.sigmoid(x)
def _layernorm(x, axis=-1, eps=1e-5):
    m = x.mean(dim=axis, keepdim=True)
    v = x.var(dim=axis, keepdim=True, unbiased=False)
    return (x - m) / torch.sqrt(v + eps)
def _scatter_add(tgt, idx, src, axis=0):
    return tgt.clone().index_add_(axis, idx, src)
def _segment_sum(src, seg, n):
    out = torch.zeros((n,) + src.shape[1:], dtype=src.dtype)
    return out.index_add_(0, seg, src)
def _pad(x, pw):
    flat = tuple(v for pair in reversed(pw) for v in pair)
    return torch.nn.functional.pad(x, flat)

kernel_name = 'sequential_preLN__gqa_block_cached__dense_activation_relu__decode'

def setup_inputs():

    _w = (lambda a: (lambda t: t.to(torch.bfloat16) if t.is_floating_point() else t)(torch.as_tensor(a)))
    def _A_setup():
        B, Sq, D = 4, 1, 512
        Hq, Hkv, Sk, Dh = 32, 32, 8192, 128
        assert Hq % Hkv == 0, (Hq, Hkv)
        return {
            "x": _w((lambda *s: torch.randn(*s, dtype=torch.bfloat16) * 0.05)(B, Sq, D)),
            "k_cache": _w((lambda *s: torch.randn(*s, dtype=torch.bfloat16) * 3.2)(B, Hkv, Sk, Dh)),
            "v_cache": _w((lambda *s: torch.randn(*s, dtype=torch.bfloat16) * 0.4)(B, Hkv, Sk, Dh)),
            "wq": _w((lambda *s: torch.randn(*s, dtype=torch.bfloat16) * 3.2)(D, Hq * Dh) * (D ** -0.5)),
            "wo": _w((lambda *s: torch.randn(*s, dtype=torch.bfloat16) * 0.4)(Hq * Dh, D) * ((Hq * Dh) ** -0.5)),
        }
    _A_in = _A_setup()

    def _B_setup():
        B, S, D, Dff = 4, 1, 512, 1376
        return {
            "x": _w((lambda *s: torch.randn(*s, dtype=torch.bfloat16) * 0.05)(B, S, D)),
            "w1": _w((lambda *s: torch.randn(*s, dtype=torch.bfloat16) * 0.05)(D, Dff)),
            "w2": _w((lambda *s: torch.randn(*s, dtype=torch.bfloat16) * 0.05)(Dff, D)),
        }
    _B_in = _B_setup()

    return {
        "A_x": _A_in["x"],
        "A_k_cache": _A_in["k_cache"],
        "A_v_cache": _A_in["v_cache"],
        "A_wq": _A_in["wq"],
        "A_wo": _A_in["wo"],
        "B_x": _B_in["x"],
        "B_w1": _B_in["w1"],
        "B_w2": _B_in["w2"],
    }

def reference(A_x, A_k_cache, A_v_cache, A_wq, A_wo, B_x, B_w1, B_w2):
    def _A_ref(x, k_cache, v_cache, wq, wo):
        B, Sq, D = x.shape
        Hq, Dh = 32, 128
        Hkv = k_cache.shape[1]
        rep = Hq // Hkv
        q = (lambda x, *d: x.permute(*d))((x @ wq).reshape(B, Sq, Hq, Dh), 0, 2, 1, 3)
        k = (lambda x, n, axis: torch.repeat_interleave(x, n, dim=axis))(k_cache, rep, axis=1)
        v = (lambda x, n, axis: torch.repeat_interleave(x, n, dim=axis))(v_cache, rep, axis=1)
        scores = torch.einsum("bhqd,bhkd->bhqk", q, k) * (Dh ** -0.5)
        p = _softmax(scores, axis=-1)
        o = torch.einsum("bhqk,bhkd->bhqd", p, v)
        return (lambda x, *d: x.permute(*d))(o, 0, 2, 1, 3).reshape(B, Sq, Hq * Dh) @ wo

    def _B_ref(x, w1, w2):
        h = torch.einsum("bsd,df->bsf", x, w1)
        zero = torch.zeros_like(h)
        h = torch.maximum(h, zero)
        return torch.einsum("bsf,fd->bsd", h, w2)

    x = A_x
    h = x + _A_ref(_layernorm(x, axis=-1), A_k_cache, A_v_cache, A_wq, A_wo)
    h2 = h + _B_ref(_layernorm(h, axis=-1), B_w1, B_w2)
    return h2
```

```asm
; @launch grid=(256,1,1) block=(512,1,1) lds=81920
.amdgcn_target "amdgcn-amd-amdhsa--gfx950"
.text
.globl sequential_preLN__gqa_block_cached__dense_activation_relu__decode_kernel
.p2align 8
.type sequential_preLN__gqa_block_cached__dense_activation_relu__decode_kernel,@function
sequential_preLN__gqa_block_cached__dense_activation_relu__decode_kernel:
s_cmp_ge_u32 s2, 256
s_cbranch_scc1 L_end
s_load_dwordx16 s[36:51], s[0:1], 0
s_load_dwordx4 s[52:55], s[0:1], 64
s_load_dwordx2 s[56:57], s[0:1], 80
v_lshrrev_b32 v1, 6, v0
v_and_b32 v2, 63, v0
s_and_b32 s58, s2, 7
v_readfirstlane_b32 s3, v1
s_lshr_b32 s59, s2, 3
s_lshr_b32 s28, s59, 3
s_lshl_b32 s28, s28, 3
s_add_u32 s28, s28, s58
s_and_b32 s59, s59, 7
s_lshr_b32 s29, s59, 1
s_and_b32 s30, s59, 1
s_lshl_b32 s31, s29, 5
s_add_u32 s31, s31, s28
s_lshl_b32 s31, s31, 1
s_add_u32 s31, s31, s30
s_lshl_b32 s62, s28, 1
s_add_u32 s62, s62, s30
s_cmp_ge_u32 s3, 4
s_cbranch_scc1 L_helper
s_getpc_b64 s[58:59]
L_pc:
s_sub_u32 s58, s58, L_pc-sequential_preLN__gqa_block_cached__dense_activation_relu__decode_kernel
s_subb_u32 s59, s59, 0
v_lshlrev_b32 v40, 7, v2
s_lshl_b32 s60, s3, 13
v_add_u32 v40, s60, v40
v_min_u32 v40, L_end-sequential_preLN__gqa_block_cached__dense_activation_relu__decode_kernel, v40
global_load_dword v41, v40, s[58:59]
v_lshlrev_b32 v3, 4, v2
s_mul_i32 s58, s3, 2048
v_add_u32 v3, s58, v3
s_lshr_b32 s58, s31, 1
s_lshl_b32 s58, s58, 21
s_lshl_b32 s61, s30, 16
s_add_u32 s58, s58, s61
s_sub_u32 s61, 2097152, s61
s_waitcnt lgkmcnt(0)
s_add_u32 s4, s38, s58
s_addc_u32 s5, s39, 0
s_mov_b32 s6, 1048576
s_mov_b32 s7, 0x20000
s_mov_b32 s6, s61
s_mov_b32 s35, 0
s_mov_b32 s32, s35
buffer_load_dwordx4 v[64:67], v3, s[4:7], s32 offen nt
s_add_u32 s32, s32, 1024
buffer_load_dwordx4 v[68:71], v3, s[4:7], s32 offen nt
s_add_u32 s32, s32, 7168
buffer_load_dwordx4 v[72:75], v3, s[4:7], s32 offen nt
s_add_u32 s32, s32, 1024
buffer_load_dwordx4 v[76:79], v3, s[4:7], s32 offen nt
s_add_u32 s32, s32, 7168
buffer_load_dwordx4 v[80:83], v3, s[4:7], s32 offen nt
s_add_u32 s32, s32, 1024
s_barrier
s_waitcnt vmcnt(4)
buffer_load_dwordx4 v[84:87], v3, s[4:7], s32 offen nt
s_add_u32 s32, s32, 7168
s_waitcnt vmcnt(4)
buffer_load_dwordx4 v[88:91], v3, s[4:7], s32 offen nt
s_add_u32 s32, s32, 1024
s_waitcnt vmcnt(4)
buffer_load_dwordx4 v[92:95], v3, s[4:7], s32 offen nt
s_add_u32 s32, s32, 7168
s_waitcnt vmcnt(4)
buffer_load_dwordx4 v[96:99], v3, s[4:7], s32 offen nt
s_add_u32 s32, s32, 1024
s_waitcnt vmcnt(4)
buffer_load_dwordx4 v[100:103], v3, s[4:7], s32 offen nt
s_add_u32 s32, s32, 7168
s_waitcnt vmcnt(4)
buffer_load_dwordx4 v[104:107], v3, s[4:7], s32 offen nt
s_add_u32 s32, s32, 1024
s_waitcnt vmcnt(4)
buffer_load_dwordx4 v[108:111], v3, s[4:7], s32 offen nt
s_add_u32 s32, s32, 7168
s_waitcnt vmcnt(4)
buffer_load_dwordx4 v[112:115], v3, s[4:7], s32 offen nt
s_add_u32 s32, s32, 1024
s_waitcnt vmcnt(4)
buffer_load_dwordx4 v[116:119], v3, s[4:7], s32 offen nt
s_add_u32 s32, s32, 7168
s_waitcnt vmcnt(4)
buffer_load_dwordx4 v[120:123], v3, s[4:7], s32 offen nt
s_add_u32 s32, s32, 1024
s_waitcnt vmcnt(4)
buffer_load_dwordx4 v[124:127], v3, s[4:7], s32 offen nt
s_add_u32 s32, s32, 72704
s_waitcnt vmcnt(4)
buffer_load_dwordx4 v[160:163], v3, s[4:7], s32 offen nt
s_add_u32 s32, s32, 1024
s_waitcnt vmcnt(4)
buffer_load_dwordx4 v[164:167], v3, s[4:7], s32 offen nt
s_add_u32 s32, s32, 7168
s_waitcnt vmcnt(4)
buffer_load_dwordx4 v[168:171], v3, s[4:7], s32 offen nt
s_add_u32 s32, s32, 1024
s_waitcnt vmcnt(4)
buffer_load_dwordx4 v[172:175], v3, s[4:7], s32 offen nt
s_add_u32 s32, s32, 7168
s_waitcnt vmcnt(4)
buffer_load_dwordx4 v[176:179], v3, s[4:7], s32 offen nt
s_add_u32 s32, s32, 1024
s_waitcnt vmcnt(4)
buffer_load_dwordx4 v[180:183], v3, s[4:7], s32 offen nt
s_add_u32 s32, s32, 7168
s_waitcnt vmcnt(4)
buffer_load_dwordx4 v[184:187], v3, s[4:7], s32 offen nt
s_add_u32 s32, s32, 1024
s_waitcnt vmcnt(4)
buffer_load_dwordx4 v[188:191], v3, s[4:7], s32 offen nt
s_add_u32 s32, s32, 7168
s_add_u32 s8, s40, s58
s_addc_u32 s9, s41, 0
s_mov_b32 s10, 1048576
s_mov_b32 s11, 0x20000
s_mov_b32 s10, s61
s_mov_b32 s12, s4
s_mov_b32 s13, s5
s_mov_b32 s14, s6
s_mov_b32 s15, s7
s_mov_b32 s16, s56
s_mov_b32 s17, s57
s_mov_b32 s18, 7344128
s_mov_b32 s19, 0x20000
s_mov_b32 s24, 0xaaaaaaaa
s_mov_b32 s25, 0xaaaaaaaa
s_mov_b32 s26, 0xcccccccc
s_mov_b32 s27, 0xcccccccc
s_lshl_b32 s60, s3, 12
s_add_u32 s60, s60, 16384
v_lshlrev_b32 v36, 2, v2
v_add_u32 v36, s60, v36
v_mov_b32 v34, 0xff7fffff
v_and_b32 v42, 15, v2
v_lshlrev_b32 v42, 5, v42
s_barrier
buffer_load_dwordx4 v[208:211], v3, s[4:7], s32 offen nt
s_add_u32 s32, s32, 1024
buffer_load_dwordx4 v[212:215], v3, s[4:7], s32 offen nt
s_add_u32 s32, s32, 7168
buffer_load_dwordx4 v[216:219], v3, s[4:7], s32 offen nt
s_add_u32 s32, s32, 1024
buffer_load_dwordx4 v[220:223], v3, s[4:7], s32 offen nt
s_add_u32 s32, s32, 7168
buffer_load_dwordx4 v[224:227], v3, s[4:7], s32 offen nt
s_add_u32 s32, s32, 1024
ds_read_b128 v[128:131], v42 offset:0
ds_read_b128 v[132:135], v42 offset:16
ds_read_b128 v[136:139], v42 offset:512
ds_read_b128 v[140:143], v42 offset:528
ds_read_b128 v[144:147], v42 offset:1024
ds_read_b128 v[148:151], v42 offset:1040
ds_read_b128 v[152:155], v42 offset:1536
ds_read_b128 v[156:159], v42 offset:1552
s_waitcnt lgkmcnt(0)
v_add_f32 v128, v128, v136
v_add_f32 v144, v144, v152
v_add_f32 v129, v129, v137
v_add_f32 v145, v145, v153
v_add_f32 v130, v130, v138
v_add_f32 v146, v146, v154
v_add_f32 v131, v131, v139
v_add_f32 v147, v147, v155
v_add_f32 v132, v132, v140
v_add_f32 v148, v148, v156
v_add_f32 v133, v133, v141
v_add_f32 v149, v149, v157
v_add_f32 v134, v134, v142
v_add_f32 v150, v150, v158
v_add_f32 v135, v135, v143
v_add_f32 v151, v151, v159
v_add_f32 v128, v128, v144
v_add_f32 v129, v129, v145
v_add_f32 v130, v130, v146
v_add_f32 v131, v131, v147
v_add_f32 v132, v132, v148
v_add_f32 v133, v133, v149
v_add_f32 v134, v134, v150
v_add_f32 v135, v135, v151
v_cvt_pk_bf16_f32 v4, v128, v129
v_cvt_pk_bf16_f32 v5, v130, v131
v_cvt_pk_bf16_f32 v6, v132, v133
v_cvt_pk_bf16_f32 v7, v134, v135
s_mov_b32 s33, 0
s_waitcnt vmcnt(28)
v_dot2_f32_bf16 v16, v64, v4, 0
v_dot2_f32_bf16 v16, v65, v5, v16
v_dot2_f32_bf16 v16, v66, v6, v16
v_dot2_f32_bf16 v16, v67, v7, v16
s_waitcnt vmcnt(27)
v_dot2_f32_bf16 v17, v68, v4, 0
v_dot2_f32_bf16 v17, v69, v5, v17
v_dot2_f32_bf16 v17, v70, v6, v17
v_dot2_f32_bf16 v17, v71, v7, v17
s_waitcnt vmcnt(26)
v_dot2_f32_bf16 v18, v72, v4, 0
v_dot2_f32_bf16 v18, v73, v5, v18
v_dot2_f32_bf16 v18, v74, v6, v18
v_dot2_f32_bf16 v18, v75, v7, v18
v_add_f32_dpp v16, v16, v16 row_ror:8 row_mask:0xf bank_mask:0x3
v_add_f32_dpp v16, v17, v17 row_ror:8 row_mask:0xf bank_mask:0xc
s_waitcnt vmcnt(25)
v_dot2_f32_bf16 v19, v76, v4, 0
v_dot2_f32_bf16 v19, v77, v5, v19
v_dot2_f32_bf16 v19, v78, v6, v19
v_dot2_f32_bf16 v19, v79, v7, v19
s_waitcnt vmcnt(24)
v_dot2_f32_bf16 v20, v80, v4, 0
v_dot2_f32_bf16 v20, v81, v5, v20
v_dot2_f32_bf16 v20, v82, v6, v20
v_dot2_f32_bf16 v20, v83, v7, v20
v_add_f32_dpp v18, v18, v18 row_ror:8 row_mask:0xf bank_mask:0x3
v_add_f32_dpp v18, v19, v19 row_ror:8 row_mask:0xf bank_mask:0xc
s_waitcnt vmcnt(23)
v_dot2_f32_bf16 v21, v84, v4, 0
v_dot2_f32_bf16 v21, v85, v5, v21
v_dot2_f32_bf16 v21, v86, v6, v21
v_dot2_f32_bf16 v21, v87, v7, v21
v_add_f32_dpp v16, v16, v16 row_shl:4 row_mask:0xf bank_mask:0x5
v_add_f32_dpp v16, v18, v18 row_shr:4 row_mask:0xf bank_mask:0xa
s_waitcnt vmcnt(22)
v_dot2_f32_bf16 v22, v88, v4, 0
v_dot2_f32_bf16 v22, v89, v5, v22
v_dot2_f32_bf16 v22, v90, v6, v22
v_dot2_f32_bf16 v22, v91, v7, v22
v_add_f32_dpp v20, v20, v20 row_ror:8 row_mask:0xf bank_mask:0x3
v_add_f32_dpp v20, v21, v21 row_ror:8 row_mask:0xf bank_mask:0xc
s_waitcnt vmcnt(21)
v_dot2_f32_bf16 v23, v92, v4, 0
v_dot2_f32_bf16 v23, v93, v5, v23
v_dot2_f32_bf16 v23, v94, v6, v23
v_dot2_f32_bf16 v23, v95, v7, v23
s_waitcnt vmcnt(20)
v_dot2_f32_bf16 v24, v96, v4, 0
v_dot2_f32_bf16 v24, v97, v5, v24
v_dot2_f32_bf16 v24, v98, v6, v24
v_dot2_f32_bf16 v24, v99, v7, v24
v_add_f32_dpp v22, v22, v22 row_ror:8 row_mask:0xf bank_mask:0x3
v_add_f32_dpp v22, v23, v23 row_ror:8 row_mask:0xf bank_mask:0xc
s_waitcnt vmcnt(19)
v_dot2_f32_bf16 v25, v100, v4, 0
v_dot2_f32_bf16 v25, v101, v5, v25
v_dot2_f32_bf16 v25, v102, v6, v25
v_dot2_f32_bf16 v25, v103, v7, v25
v_add_f32_dpp v20, v20, v20 row_shl:4 row_mask:0xf bank_mask:0x5
v_add_f32_dpp v20, v22, v22 row_shr:4 row_mask:0xf bank_mask:0xa
s_waitcnt vmcnt(18)
v_dot2_f32_bf16 v26, v104, v4, 0
v_dot2_f32_bf16 v26, v105, v5, v26
v_dot2_f32_bf16 v26, v106, v6, v26
v_dot2_f32_bf16 v26, v107, v7, v26
v_add_f32_dpp v24, v24, v24 row_ror:8 row_mask:0xf bank_mask:0x3
v_add_f32_dpp v24, v25, v25 row_ror:8 row_mask:0xf bank_mask:0xc
s_waitcnt vmcnt(17)
v_dot2_f32_bf16 v27, v108, v4, 0
v_dot2_f32_bf16 v27, v109, v5, v27
v_dot2_f32_bf16 v27, v110, v6, v27
v_dot2_f32_bf16 v27, v111, v7, v27
v_add_f32_dpp v32, v16, v16 quad_perm:[2,3,0,1] row_mask:0xf bank_mask:0xf
v_add_f32_dpp v33, v20, v20 quad_perm:[2,3,0,1] row_mask:0xf bank_mask:0xf
v_cndmask_b32 v44, v32, v33, s[26:27]
s_waitcnt vmcnt(16)
v_dot2_f32_bf16 v28, v112, v4, 0
v_dot2_f32_bf16 v28, v113, v5, v28
v_dot2_f32_bf16 v28, v114, v6, v28
v_dot2_f32_bf16 v28, v115, v7, v28
v_add_f32_dpp v26, v26, v26 row_ror:8 row_mask:0xf bank_mask:0x3
v_add_f32_dpp v26, v27, v27 row_ror:8 row_mask:0xf bank_mask:0xc
s_waitcnt vmcnt(15)
v_dot2_f32_bf16 v29, v116, v4, 0
v_dot2_f32_bf16 v29, v117, v5, v29
v_dot2_f32_bf16 v29, v118, v6, v29
v_dot2_f32_bf16 v29, v119, v7, v29
v_add_f32_dpp v24, v24, v24 row_shl:4 row_mask:0xf bank_mask:0x5
v_add_f32_dpp v24, v26, v26 row_shr:4 row_mask:0xf bank_mask:0xa
s_waitcnt vmcnt(14)
v_dot2_f32_bf16 v30, v120, v4, 0
v_dot2_f32_bf16 v30, v121, v5, v30
v_dot2_f32_bf16 v30, v122, v6, v30
v_dot2_f32_bf16 v30, v123, v7, v30
v_add_f32_dpp v28, v28, v28 row_ror:8 row_mask:0xf bank_mask:0x3
v_add_f32_dpp v28, v29, v29 row_ror:8 row_mask:0xf bank_mask:0xc
s_waitcnt vmcnt(13)
v_dot2_f32_bf16 v31, v124, v4, 0
v_dot2_f32_bf16 v31, v125, v5, v31
v_dot2_f32_bf16 v31, v126, v6, v31
v_dot2_f32_bf16 v31, v127, v7, v31
s_waitcnt vmcnt(12)
v_dot2_f32_bf16 v16, v160, v4, 0
v_dot2_f32_bf16 v16, v161, v5, v16
v_dot2_f32_bf16 v16, v162, v6, v16
v_dot2_f32_bf16 v16, v163, v7, v16
v_add_f32_dpp v30, v30, v30 row_ror:8 row_mask:0xf bank_mask:0x3
v_add_f32_dpp v30, v31, v31 row_ror:8 row_mask:0xf bank_mask:0xc
s_waitcnt vmcnt(11)
v_dot2_f32_bf16 v17, v164, v4, 0
v_dot2_f32_bf16 v17, v165, v5, v17
v_dot2_f32_bf16 v17, v166, v6, v17
v_dot2_f32_bf16 v17, v167, v7, v17
v_add_f32_dpp v28, v28, v28 row_shl:4 row_mask:0xf bank_mask:0x5
v_add_f32_dpp v28, v30, v30 row_shr:4 row_mask:0xf bank_mask:0xa
s_waitcnt vmcnt(10)
v_dot2_f32_bf16 v18, v168, v4, 0
v_dot2_f32_bf16 v18, v169, v5, v18
v_dot2_f32_bf16 v18, v170, v6, v18
v_dot2_f32_bf16 v18, v171, v7, v18
v_add_f32_dpp v32, v24, v24 quad_perm:[2,3,0,1] row_mask:0xf bank_mask:0xf
v_add_f32_dpp v33, v28, v28 quad_perm:[2,3,0,1] row_mask:0xf bank_mask:0xf
v_cndmask_b32 v45, v32, v33, s[26:27]
v_add_f32_dpp v16, v16, v16 row_ror:8 row_mask:0xf bank_mask:0x3
v_add_f32_dpp v16, v17, v17 row_ror:8 row_mask:0xf bank_mask:0xc
s_waitcnt vmcnt(9)
v_dot2_f32_bf16 v19, v172, v4, 0
v_dot2_f32_bf16 v19, v173, v5, v19
v_dot2_f32_bf16 v19, v174, v6, v19
v_dot2_f32_bf16 v19, v175, v7, v19
v_add_f32_dpp v32, v44, v44 quad_perm:[1,0,3,2] row_mask:0xf bank_mask:0xf
v_add_f32_dpp v33, v45, v45 quad_perm:[1,0,3,2] row_mask:0xf bank_mask:0xf
v_cndmask_b32 v46, v32, v33, s[24:25]
s_waitcnt vmcnt(8)
v_dot2_f32_bf16 v20, v176, v4, 0
v_dot2_f32_bf16 v20, v177, v5, v20
v_dot2_f32_bf16 v20, v178, v6, v20
v_dot2_f32_bf16 v20, v179, v7, v20
v_cvt_pk_bf16_f32 v46, v46, v46
v_and_b32 v46, 0xffff0000, v46
v_add_f32_dpp v18, v18, v18 row_ror:8 row_mask:0xf bank_mask:0x3
v_add_f32_dpp v18, v19, v19 row_ror:8 row_mask:0xf bank_mask:0xc
s_waitcnt vmcnt(7)
v_dot2_f32_bf16 v21, v180, v4, 0
v_dot2_f32_bf16 v21, v181, v5, v21
v_dot2_f32_bf16 v21, v182, v6, v21
v_dot2_f32_bf16 v21, v183, v7, v21
v_mul_f32 v46, 0x3db504f3, v46
v_cvt_pk_bf16_f32 v46, v46, v46
v_add_f32_dpp v16, v16, v16 row_shl:4 row_mask:0xf bank_mask:0x5
v_add_f32_dpp v16, v18, v18 row_shr:4 row_mask:0xf bank_mask:0xa
s_waitcnt vmcnt(6)
v_dot2_f32_bf16 v22, v184, v4, 0
v_dot2_f32_bf16 v22, v185, v5, v22
v_dot2_f32_bf16 v22, v186, v6, v22
v_dot2_f32_bf16 v22, v187, v7, v22
v_and_b32 v46, 0xffff0000, v46
v_max_f32 v34, v34, v46
ds_write_b32 v36, v46
v_add_u32 v36, 256, v36
v_add_f32_dpp v20, v20, v20 row_ror:8 row_mask:0xf bank_mask:0x3
v_add_f32_dpp v20, v21, v21 row_ror:8 row_mask:0xf bank_mask:0xc
s_waitcnt vmcnt(5)
v_dot2_f32_bf16 v23, v188, v4, 0
v_dot2_f32_bf16 v23, v189, v5, v23
v_dot2_f32_bf16 v23, v190, v6, v23
v_dot2_f32_bf16 v23, v191, v7, v23
s_waitcnt vmcnt(4)
buffer_load_dwordx4 v[116:119], v3, s[12:15], s32 offen nt
s_add_u32 s32, s32, 7168
v_dot2_f32_bf16 v24, v208, v4, 0
v_dot2_f32_bf16 v24, v209, v5, v24
v_dot2_f32_bf16 v24, v210, v6, v24
v_dot2_f32_bf16 v24, v211, v7, v24
v_add_f32_dpp v22, v22, v22 row_ror:8 row_mask:0xf bank_mask:0x3
v_add_f32_dpp v22, v23, v23 row_ror:8 row_mask:0xf bank_mask:0xc
s_waitcnt vmcnt(4)
buffer_load_dwordx4 v[120:123], v3, s[12:15], s32 offen nt
s_add_u32 s32, s32, 1024
v_dot2_f32_bf16 v25, v212, v4, 0
v_dot2_f32_bf16 v25, v213, v5, v25
v_dot2_f32_bf16 v25, v214, v6, v25
v_dot2_f32_bf16 v25, v215, v7, v25
v_add_f32_dpp v20, v20, v20 row_shl:4 row_mask:0xf bank_mask:0x5
v_add_f32_dpp v20, v22, v22 row_shr:4 row_mask:0xf bank_mask:0xa
s_waitcnt vmcnt(4)
buffer_load_dwordx4 v[124:127], v3, s[12:15], s32 offen nt
s_add_u32 s32, s32, 72704
v_dot2_f32_bf16 v26, v216, v4, 0
v_dot2_f32_bf16 v26, v217, v5, v26
v_dot2_f32_bf16 v26, v218, v6, v26
v_dot2_f32_bf16 v26, v219, v7, v26
v_add_f32_dpp v24, v24, v24 row_ror:8 row_mask:0xf bank_mask:0x3
v_add_f32_dpp v24, v25, v25 row_ror:8 row_mask:0xf bank_mask:0xc
s_waitcnt vmcnt(4)
buffer_load_dwordx4 v[64:67], v3, s[12:15], s32 offen nt
s_add_u32 s32, s32, 1024
v_dot2_f32_bf16 v27, v220, v4, 0
v_dot2_f32_bf16 v27, v221, v5, v27
v_dot2_f32_bf16 v27, v222, v6, v27
v_dot2_f32_bf16 v27, v223, v7, v27
v_add_f32_dpp v32, v16, v16 quad_perm:[2,3,0,1] row_mask:0xf bank_mask:0xf
v_add_f32_dpp v33, v20, v20 quad_perm:[2,3,0,1] row_mask:0xf bank_mask:0xf
v_cndmask_b32 v44, v32, v33, s[26:27]
s_waitcnt vmcnt(4)
buffer_load_dwordx4 v[68:71], v3, s[12:15], s32 offen nt
s_add_u32 s32, s32, 7168
v_dot2_f32_bf16 v28, v224, v4, 0
v_dot2_f32_bf16 v28, v225, v5, v28
v_dot2_f32_bf16 v28, v226, v6, v28
v_dot2_f32_bf16 v28, v227, v7, v28
v_add_f32_dpp v26, v26, v26 row_ror:8 row_mask:0xf bank_mask:0x3
v_add_f32_dpp v26, v27, v27 row_ror:8 row_mask:0xf bank_mask:0xc
s_waitcnt vmcnt(4)
buffer_load_dwordx4 v[72:75], v3, s[12:15], s32 offen nt
s_add_u32 s32, s32, 1024
v_dot2_f32_bf16 v29, v116, v4, 0
v_dot2_f32_bf16 v29, v117, v5, v29
v_dot2_f32_bf16 v29, v118, v6, v29
v_dot2_f32_bf16 v29, v119, v7, v29
v_add_f32_dpp v24, v24, v24 row_shl:4 row_mask:0xf bank_mask:0x5
v_add_f32_dpp v24, v26, v26 row_shr:4 row_mask:0xf bank_mask:0xa
s_waitcnt vmcnt(4)
buffer_load_dwordx4 v[76:79], v3, s[12:15], s32 offen nt
s_add_u32 s32, s32, 7168
v_dot2_f32_bf16 v30, v120, v4, 0
v_dot2_f32_bf16 v30, v121, v5, v30
v_dot2_f32_bf16 v30, v122, v6, v30
v_dot2_f32_bf16 v30, v123, v7, v30
v_add_f32_dpp v28, v28, v28 row_ror:8 row_mask:0xf bank_mask:0x3
v_add_f32_dpp v28, v29, v29 row_ror:8 row_mask:0xf bank_mask:0xc
s_waitcnt vmcnt(4)
buffer_load_dwordx4 v[80:83], v3, s[12:15], s32 offen nt
s_add_u32 s32, s32, 1024
v_dot2_f32_bf16 v31, v124, v4, 0
v_dot2_f32_bf16 v31, v125, v5, v31
v_dot2_f32_bf16 v31, v126, v6, v31
v_dot2_f32_bf16 v31, v127, v7, v31
s_mov_b32 s33, 2
v_mov_b32 v43, 4184
L_kloop:
s_waitcnt vmcnt(4)
buffer_load_dwordx4 v[84:87], v3, s[12:15], s32 offen nt
s_add_u32 s32, s32, 7168
v_dot2_f32_bf16 v16, v64, v4, 0
v_dot2_f32_bf16 v16, v65, v5, v16
v_dot2_f32_bf16 v16, v66, v6, v16
v_dot2_f32_bf16 v16, v67, v7, v16
v_add_f32_dpp v30, v30, v30 row_ror:8 row_mask:0xf bank_mask:0x3
v_add_f32_dpp v30, v31, v31 row_ror:8 row_mask:0xf bank_mask:0xc
s_waitcnt vmcnt(4)
buffer_load_dwordx4 v[88:91], v3, s[12:15], s32 offen nt
s_add_u32 s32, s32, 1024
v_dot2_f32_bf16 v17, v68, v4, 0
v_dot2_f32_bf16 v17, v69, v5, v17
v_dot2_f32_bf16 v17, v70, v6, v17
v_dot2_f32_bf16 v17, v71, v7, v17
v_add_f32_dpp v28, v28, v28 row_shl:4 row_mask:0xf bank_mask:0x5
v_add_f32_dpp v28, v30, v30 row_shr:4 row_mask:0xf bank_mask:0xa
s_waitcnt vmcnt(4)
buffer_load_dwordx4 v[92:95], v3, s[12:15], s32 offen nt
s_add_u32 s32, s32, 7168
v_dot2_f32_bf16 v18, v72, v4, 0
v_dot2_f32_bf16 v18, v73, v5, v18
v_dot2_f32_bf16 v18, v74, v6, v18
v_dot2_f32_bf16 v18, v75, v7, v18
v_add_f32_dpp v32, v24, v24 quad_perm:[2,3,0,1] row_mask:0xf bank_mask:0xf
v_add_f32_dpp v33, v28, v28 quad_perm:[2,3,0,1] row_mask:0xf bank_mask:0xf
v_cndmask_b32 v45, v32, v33, s[26:27]
v_add_f32_dpp v16, v16, v16 row_ror:8 row_mask:0xf bank_mask:0x3
v_add_f32_dpp v16, v17, v17 row_ror:8 row_mask:0xf bank_mask:0xc
s_waitcnt vmcnt(4)
buffer_load_dwordx4 v[96:99], v3, s[12:15], s32 offen nt
s_add_u32 s32, s32, 1024
v_dot2_f32_bf16 v19, v76, v4, 0
v_dot2_f32_bf16 v19, v77, v5, v19
v_dot2_f32_bf16 v19, v78, v6, v19
v_dot2_f32_bf16 v19, v79, v7, v19
v_add_f32_dpp v32, v44, v44 quad_perm:[1,0,3,2] row_mask:0xf bank_mask:0xf
v_add_f32_dpp v33, v45, v45 quad_perm:[1,0,3,2] row_mask:0xf bank_mask:0xf
v_cndmask_b32 v46, v32, v33, s[24:25]
s_waitcnt vmcnt(4)
buffer_load_dwordx4 v[100:103], v3, s[12:15], s32 offen nt
s_add_u32 s32, s32, 7168
v_dot2_f32_bf16 v20, v80, v4, 0
v_dot2_f32_bf16 v20, v81, v5, v20
v_dot2_f32_bf16 v20, v82, v6, v20
v_dot2_f32_bf16 v20, v83, v7, v20
v_cvt_pk_bf16_f32 v46, v46, v46
v_and_b32 v46, 0xffff0000, v46
v_add_f32_dpp v18, v18, v18 row_ror:8 row_mask:0xf bank_mask:0x3
v_add_f32_dpp v18, v19, v19 row_ror:8 row_mask:0xf bank_mask:0xc
s_waitcnt vmcnt(4)
buffer_load_dwordx4 v[104:107], v3, s[12:15], s32 offen nt
s_add_u32 s32, s32, 1024
v_dot2_f32_bf16 v21, v84, v4, 0
v_dot2_f32_bf16 v21, v85, v5, v21
v_dot2_f32_bf16 v21, v86, v6, v21
v_dot2_f32_bf16 v21, v87, v7, v21
v_mul_f32 v46, 0x3db504f3, v46
v_cvt_pk_bf16_f32 v46, v46, v46
v_add_f32_dpp v16, v16, v16 row_shl:4 row_mask:0xf bank_mask:0x5
v_add_f32_dpp v16, v18, v18 row_shr:4 row_mask:0xf bank_mask:0xa
s_waitcnt vmcnt(4)
buffer_load_dwordx4 v[108:111], v3, s[12:15], s32 offen nt
s_add_u32 s32, s32, 7168
v_dot2_f32_bf16 v22, v88, v4, 0
v_dot2_f32_bf16 v22, v89, v5, v22
v_dot2_f32_bf16 v22, v90, v6, v22
v_dot2_f32_bf16 v22, v91, v7, v22
v_and_b32 v46, 0xffff0000, v46
v_max_f32 v34, v34, v46
ds_write_b32 v36, v46
v_add_u32 v36, 256, v36
v_add_f32_dpp v20, v20, v20 row_ror:8 row_mask:0xf bank_mask:0x3
v_add_f32_dpp v20, v21, v21 row_ror:8 row_mask:0xf bank_mask:0xc
s_waitcnt vmcnt(4)
buffer_load_dwordx4 v[112:115], v3, s[12:15], s32 offen nt
s_add_u32 s32, s32, 1024
v_dot2_f32_bf16 v23, v92, v4, 0
v_dot2_f32_bf16 v23, v93, v5, v23
v_dot2_f32_bf16 v23, v94, v6, v23
v_dot2_f32_bf16 v23, v95, v7, v23
s_waitcnt vmcnt(4)
buffer_load_dwordx4 v[116:119], v3, s[12:15], s32 offen nt
s_add_u32 s32, s32, 7168
v_dot2_f32_bf16 v24, v96, v4, 0
v_dot2_f32_bf16 v24, v97, v5, v24
v_dot2_f32_bf16 v24, v98, v6, v24
v_dot2_f32_bf16 v24, v99, v7, v24
v_add_f32_dpp v22, v22, v22 row_ror:8 row_mask:0xf bank_mask:0x3
v_add_f32_dpp v22, v23, v23 row_ror:8 row_mask:0xf bank_mask:0xc
s_waitcnt vmcnt(4)
buffer_load_dwordx4 v[120:123], v3, s[12:15], s32 offen nt
s_add_u32 s32, s32, 1024
v_dot2_f32_bf16 v25, v100, v4, 0
v_dot2_f32_bf16 v25, v101, v5, v25
v_dot2_f32_bf16 v25, v102, v6, v25
v_dot2_f32_bf16 v25, v103, v7, v25
v_add_f32_dpp v20, v20, v20 row_shl:4 row_mask:0xf bank_mask:0x5
v_add_f32_dpp v20, v22, v22 row_shr:4 row_mask:0xf bank_mask:0xa
s_waitcnt vmcnt(4)
buffer_load_dwordx4 v[124:127], v3, s[12:15], s32 offen nt
s_add_u32 s32, s32, 72704
v_dot2_f32_bf16 v26, v104, v4, 0
v_dot2_f32_bf16 v26, v105, v5, v26
v_dot2_f32_bf16 v26, v106, v6, v26
v_dot2_f32_bf16 v26, v107, v7, v26
v_add_f32_dpp v24, v24, v24 row_ror:8 row_mask:0xf bank_mask:0x3
v_add_f32_dpp v24, v25, v25 row_ror:8 row_mask:0xf bank_mask:0xc
s_waitcnt vmcnt(4)
s_cmp_eq_u32 s33, 15
s_cselect_b32 s12, s8, s12
s_cselect_b32 s13, s9, s13
s_cselect_b32 s32, s35, s32
buffer_load_dwordx4 v[64:67], v3, s[12:15], s32 offen nt
s_add_u32 s32, s32, 1024
v_dot2_f32_bf16 v27, v108, v4, 0
v_dot2_f32_bf16 v27, v109, v5, v27
v_dot2_f32_bf16 v27, v110, v6, v27
v_dot2_f32_bf16 v27, v111, v7, v27
v_add_f32_dpp v32, v16, v16 quad_perm:[2,3,0,1] row_mask:0xf bank_mask:0xf
v_add_f32_dpp v33, v20, v20 quad_perm:[2,3,0,1] row_mask:0xf bank_mask:0xf
v_cndmask_b32 v44, v32, v33, s[26:27]
s_waitcnt vmcnt(4)
buffer_load_dwordx4 v[68:71], v3, s[12:15], s32 offen nt
s_add_u32 s32, s32, 7168
v_dot2_f32_bf16 v28, v112, v4, 0
v_dot2_f32_bf16 v28, v113, v5, v28
v_dot2_f32_bf16 v28, v114, v6, v28
v_dot2_f32_bf16 v28, v115, v7, v28
v_add_f32_dpp v26, v26, v26 row_ror:8 row_mask:0xf bank_mask:0x3
v_add_f32_dpp v26, v27, v27 row_ror:8 row_mask:0xf bank_mask:0xc
s_waitcnt vmcnt(4)
buffer_load_dwordx4 v[72:75], v3, s[12:15], s32 offen nt
s_add_u32 s32, s32, 1024
v_dot2_f32_bf16 v29, v116, v4, 0
v_dot2_f32_bf16 v29, v117, v5, v29
v_dot2_f32_bf16 v29, v118, v6, v29
v_dot2_f32_bf16 v29, v119, v7, v29
v_add_f32_dpp v24, v24, v24 row_shl:4 row_mask:0xf bank_mask:0x5
v_add_f32_dpp v24, v26, v26 row_shr:4 row_mask:0xf bank_mask:0xa
s_waitcnt vmcnt(4)
buffer_load_dwordx4 v[76:79], v3, s[12:15], s32 offen nt
s_add_u32 s32, s32, 7168
v_dot2_f32_bf16 v30, v120, v4, 0
v_dot2_f32_bf16 v30, v121, v5, v30
v_dot2_f32_bf16 v30, v122, v6, v30
v_dot2_f32_bf16 v30, v123, v7, v30
v_add_f32_dpp v28, v28, v28 row_ror:8 row_mask:0xf bank_mask:0x3
v_add_f32_dpp v28, v29, v29 row_ror:8 row_mask:0xf bank_mask:0xc
s_waitcnt vmcnt(4)
buffer_load_dwordx4 v[80:83], v3, s[12:15], s32 offen nt
s_add_u32 s32, s32, 1024
v_dot2_f32_bf16 v31, v124, v4, 0
v_dot2_f32_bf16 v31, v125, v5, v31
v_dot2_f32_bf16 v31, v126, v6, v31
v_dot2_f32_bf16 v31, v127, v7, v31
s_add_u32 s33, s33, 1
s_cmp_lt_u32 s33, 16
s_cbranch_scc1 L_kloop
v_add_f32_dpp v30, v30, v30 row_ror:8 row_mask:0xf bank_mask:0x3
v_add_f32_dpp v30, v31, v31 row_ror:8 row_mask:0xf bank_mask:0xc
v_add_f32_dpp v28, v28, v28 row_shl:4 row_mask:0xf bank_mask:0x5
s_nop 0
v_add_f32_dpp v28, v30, v30 row_shr:4 row_mask:0xf bank_mask:0xa
v_add_f32_dpp v32, v24, v24 quad_perm:[2,3,0,1] row_mask:0xf bank_mask:0xf
s_nop 0
v_add_f32_dpp v33, v28, v28 quad_perm:[2,3,0,1] row_mask:0xf bank_mask:0xf
v_cndmask_b32 v45, v32, v33, s[26:27]
v_add_f32_dpp v32, v44, v44 quad_perm:[1,0,3,2] row_mask:0xf bank_mask:0xf
s_nop 0
v_add_f32_dpp v33, v45, v45 quad_perm:[1,0,3,2] row_mask:0xf bank_mask:0xf
v_cndmask_b32 v46, v32, v33, s[24:25]
v_cvt_pk_bf16_f32 v46, v46, v46
v_and_b32 v46, 0xffff0000, v46
v_mul_f32 v46, 0x3db504f3, v46
v_cvt_pk_bf16_f32 v46, v46, v46
v_and_b32 v46, 0xffff0000, v46
v_max_f32 v34, v34, v46
ds_write_b32 v36, v46
v_add_u32 v36, 256, v36
v_subrev_u32 v36, 4096, v36
s_waitcnt lgkmcnt(0)
ds_read_b32 v16, v36 offset:0
ds_read_b32 v17, v36 offset:256
ds_read_b32 v18, v36 offset:512
ds_read_b32 v19, v36 offset:768
ds_read_b32 v20, v36 offset:1024
ds_read_b32 v21, v36 offset:1280
ds_read_b32 v22, v36 offset:1536
ds_read_b32 v23, v36 offset:1792
ds_read_b32 v24, v36 offset:2048
ds_read_b32 v25, v36 offset:2304
ds_read_b32 v26, v36 offset:2560
ds_read_b32 v27, v36 offset:2816
ds_read_b32 v28, v36 offset:3072
ds_read_b32 v29, v36 offset:3328
ds_read_b32 v30, v36 offset:3584
ds_read_b32 v31, v36 offset:3840
v_max_f32_dpp v34, v34, v34 row_ror:8 row_mask:0xf bank_mask:0xf
s_nop 1
v_max_f32_dpp v34, v34, v34 row_ror:4 row_mask:0xf bank_mask:0xf
s_nop 1
v_max_f32_dpp v34, v34, v34 row_ror:2 row_mask:0xf bank_mask:0xf
s_nop 1
v_max_f32_dpp v34, v34, v34 row_ror:1 row_mask:0xf bank_mask:0xf
v_mov_b32 v32, v34
s_nop 1
v_permlane16_swap_b32 v34, v32
v_max_f32 v34, v34, v32
v_mov_b32 v32, v34
s_nop 1
v_permlane32_swap_b32 v34, v32
v_max_f32 v34, v34, v32
v_mul_f32 v33, 0xbfb8aa3b, v34
s_mov_b32 s58, 0x3fb8aa3b
s_waitcnt lgkmcnt(0)
v_fma_f32 v16, v16, s58, v33
v_fma_f32 v17, v17, s58, v33
v_fma_f32 v18, v18, s58, v33
v_fma_f32 v19, v19, s58, v33
v_fma_f32 v20, v20, s58, v33
v_fma_f32 v21, v21, s58, v33
v_fma_f32 v22, v22, s58, v33
v_fma_f32 v23, v23, s58, v33
v_fma_f32 v24, v24, s58, v33
v_fma_f32 v25, v25, s58, v33
v_fma_f32 v26, v26, s58, v33
v_fma_f32 v27, v27, s58, v33
v_fma_f32 v28, v28, s58, v33
v_fma_f32 v29, v29, s58, v33
v_fma_f32 v30, v30, s58, v33
v_fma_f32 v31, v31, s58, v33
v_exp_f32 v16, v16
v_exp_f32 v17, v17
v_exp_f32 v18, v18
v_exp_f32 v19, v19
v_exp_f32 v20, v20
v_exp_f32 v21, v21
v_exp_f32 v22, v22
v_exp_f32 v23, v23
v_exp_f32 v24, v24
v_exp_f32 v25, v25
v_exp_f32 v26, v26
v_exp_f32 v27, v27
v_exp_f32 v28, v28
v_exp_f32 v29, v29
v_exp_f32 v30, v30
v_exp_f32 v31, v31
v_add_f32 v35, v16, v17
v_add_f32 v35, v35, v18
v_add_f32 v35, v35, v19
v_add_f32 v35, v35, v20
v_add_f32 v35, v35, v21
v_add_f32 v35, v35, v22
v_add_f32 v35, v35, v23
v_add_f32 v35, v35, v24
v_add_f32 v35, v35, v25
v_add_f32 v35, v35, v26
v_add_f32 v35, v35, v27
v_add_f32 v35, v35, v28
v_add_f32 v35, v35, v29
v_add_f32 v35, v35, v30
v_add_f32 v35, v35, v31
v_cvt_pk_bf16_f32 v16, v16, v16
v_cvt_pk_bf16_f32 v17, v17, v17
v_cvt_pk_bf16_f32 v18, v18, v18
v_cvt_pk_bf16_f32 v19, v19, v19
v_cvt_pk_bf16_f32 v20, v20, v20
v_cvt_pk_bf16_f32 v21, v21, v21
v_cvt_pk_bf16_f32 v22, v22, v22
v_cvt_pk_bf16_f32 v23, v23, v23
v_cvt_pk_bf16_f32 v24, v24, v24
v_cvt_pk_bf16_f32 v25, v25, v25
v_cvt_pk_bf16_f32 v26, v26, v26
v_cvt_pk_bf16_f32 v27, v27, v27
v_cvt_pk_bf16_f32 v28, v28, v28
v_cvt_pk_bf16_f32 v29, v29, v29
v_cvt_pk_bf16_f32 v30, v30, v30
v_cvt_pk_bf16_f32 v31, v31, v31
ds_write_b32 v36, v16 offset:0
ds_write_b32 v36, v17 offset:256
ds_write_b32 v36, v18 offset:512
ds_write_b32 v36, v19 offset:768
ds_write_b32 v36, v20 offset:1024
ds_write_b32 v36, v21 offset:1280
ds_write_b32 v36, v22 offset:1536
ds_write_b32 v36, v23 offset:1792
ds_write_b32 v36, v24 offset:2048
ds_write_b32 v36, v25 offset:2304
ds_write_b32 v36, v26 offset:2560
ds_write_b32 v36, v27 offset:2816
ds_write_b32 v36, v28 offset:3072
ds_write_b32 v36, v29 offset:3328
ds_write_b32 v36, v30 offset:3584
ds_write_b32 v36, v31 offset:3840
v_add_f32_dpp v35, v35, v35 row_ror:8 row_mask:0xf bank_mask:0xf
s_nop 1
v_add_f32_dpp v35, v35, v35 row_ror:4 row_mask:0xf bank_mask:0xf
s_nop 1
v_add_f32_dpp v35, v35, v35 row_ror:2 row_mask:0xf bank_mask:0xf
s_nop 1
v_add_f32_dpp v35, v35, v35 row_ror:1 row_mask:0xf bank_mask:0xf
v_mov_b32 v32, v35
s_nop 1
v_permlane16_swap_b32 v35, v32
v_add_f32 v35, v35, v32
v_mov_b32 v32, v35
s_nop 1
v_permlane32_swap_b32 v35, v32
v_add_f32 v35, v35, v32
v_mov_b32 v40, v34
v_mov_b32 v41, v35
v_mov_b32 v43, 0x7fc00000
v_cmp_eq_u32 vcc, -1, v40
s_nop 1
v_cndmask_b32 v40, v40, v43, vcc
v_cmp_eq_u32 vcc, -1, v41
s_nop 1
v_cndmask_b32 v41, v41, v43, vcc
s_lshl_b32 s58, s3, 3
s_add_u32 s58, s58, 4096
v_mov_b32 v42, s58
s_mov_b64 exec, 1
ds_write_b64 v42, v[40:41]
s_mov_b64 exec, -1
v_mov_b32 v37, v16
v_mov_b32 v8, 0
v_mov_b32 v9, 0
v_mov_b32 v10, 0
v_mov_b32 v11, 0
v_mov_b32 v12, 0
v_mov_b32 v13, 0
v_mov_b32 v14, 0
v_mov_b32 v15, 0
s_mov_b32 s33, 0
L_vloop:
v_and_b32 v38, 0xffff, v37
v_and_b32 v39, 0xffff0000, v37
v_add_u32 v36, 256, v36
ds_read_b32 v37, v36
s_waitcnt vmcnt(4)
buffer_load_dwordx4 v[84:87], v3, s[12:15], s32 offen nt
s_add_u32 s32, s32, 7168
v_dot2c_f32_bf16_dpp v8, v38, v64 row_newbcast:0 row_mask:0xf bank_mask:0xf
v_dot2c_f32_bf16_dpp v9, v39, v64 row_newbcast:0 row_mask:0xf bank_mask:0xf
v_dot2c_f32_bf16_dpp v10, v38, v65 row_newbcast:0 row_mask:0xf bank_mask:0xf
v_dot2c_f32_bf16_dpp v11, v39, v65 row_newbcast:0 row_mask:0xf bank_mask:0xf
v_dot2c_f32_bf16_dpp v12, v38, v66 row_newbcast:0 row_mask:0xf bank_mask:0xf
v_dot2c_f32_bf16_dpp v13, v39, v66 row_newbcast:0 row_mask:0xf bank_mask:0xf
v_dot2c_f32_bf16_dpp v14, v38, v67 row_newbcast:0 row_mask:0xf bank_mask:0xf
v_dot2c_f32_bf16_dpp v15, v39, v67 row_newbcast:0 row_mask:0xf bank_mask:0xf
s_waitcnt vmcnt(4)
buffer_load_dwordx4 v[88:91], v3, s[12:15], s32 offen nt
s_add_u32 s32, s32, 1024
v_dot2c_f32_bf16_dpp v8, v38, v68 row_newbcast:8 row_mask:0xf bank_mask:0xf
v_dot2c_f32_bf16_dpp v9, v39, v68 row_newbcast:8 row_mask:0xf bank_mask:0xf
v_dot2c_f32_bf16_dpp v10, v38, v69 row_newbcast:8 row_mask:0xf bank_mask:0xf
v_dot2c_f32_bf16_dpp v11, v39, v69 row_newbcast:8 row_mask:0xf bank_mask:0xf
v_dot2c_f32_bf16_dpp v12, v38, v70 row_newbcast:8 row_mask:0xf bank_mask:0xf
v_dot2c_f32_bf16_dpp v13, v39, v70 row_newbcast:8 row_mask:0xf bank_mask:0xf
v_dot2c_f32_bf16_dpp v14, v38, v71 row_newbcast:8 row_mask:0xf bank_mask:0xf
v_dot2c_f32_bf16_dpp v15, v39, v71 row_newbcast:8 row_mask:0xf bank_mask:0xf
s_waitcnt vmcnt(4)
buffer_load_dwordx4 v[92:95], v3, s[12:15], s32 offen nt
s_add_u32 s32, s32, 7168
v_dot2c_f32_bf16_dpp v8, v38, v72 row_newbcast:4 row_mask:0xf bank_mask:0xf
v_dot2c_f32_bf16_dpp v9, v39, v72 row_newbcast:4 row_mask:0xf bank_mask:0xf
v_dot2c_f32_bf16_dpp v10, v38, v73 row_newbcast:4 row_mask:0xf bank_mask:0xf
v_dot2c_f32_bf16_dpp v11, v39, v73 row_newbcast:4 row_mask:0xf bank_mask:0xf
v_dot2c_f32_bf16_dpp v12, v38, v74 row_newbcast:4 row_mask:0xf bank_mask:0xf
v_dot2c_f32_bf16_dpp v13, v39, v74 row_newbcast:4 row_mask:0xf bank_mask:0xf
v_dot2c_f32_bf16_dpp v14, v38, v75 row_newbcast:4 row_mask:0xf bank_mask:0xf
v_dot2c_f32_bf16_dpp v15, v39, v75 row_newbcast:4 row_mask:0xf bank_mask:0xf
s_waitcnt vmcnt(4)
buffer_load_dwordx4 v[96:99], v3, s[12:15], s32 offen nt
s_add_u32 s32, s32, 1024
v_dot2c_f32_bf16_dpp v8, v38, v76 row_newbcast:12 row_mask:0xf bank_mask:0xf
v_dot2c_f32_bf16_dpp v9, v39, v76 row_newbcast:12 row_mask:0xf bank_mask:0xf
v_dot2c_f32_bf16_dpp v10, v38, v77 row_newbcast:12 row_mask:0xf bank_mask:0xf
v_dot2c_f32_bf16_dpp v11, v39, v77 row_newbcast:12 row_mask:0xf bank_mask:0xf
v_dot2c_f32_bf16_dpp v12, v38, v78 row_newbcast:12 row_mask:0xf bank_mask:0xf
v_dot2c_f32_bf16_dpp v13, v39, v78 row_newbcast:12 row_mask:0xf bank_mask:0xf
v_dot2c_f32_bf16_dpp v14, v38, v79 row_newbcast:12 row_mask:0xf bank_mask:0xf
v_dot2c_f32_bf16_dpp v15, v39, v79 row_newbcast:12 row_mask:0xf bank_mask:0xf
s_waitcnt vmcnt(4)
buffer_load_dwordx4 v[100:103], v3, s[12:15], s32 offen nt
s_add_u32 s32, s32, 7168
v_dot2c_f32_bf16_dpp v8, v38, v80 row_newbcast:2 row_mask:0xf bank_mask:0xf
v_dot2c_f32_bf16_dpp v9, v39, v80 row_newbcast:2 row_mask:0xf bank_mask:0xf
v_dot2c_f32_bf16_dpp v10, v38, v81 row_newbcast:2 row_mask:0xf bank_mask:0xf
v_dot2c_f32_bf16_dpp v11, v39, v81 row_newbcast:2 row_mask:0xf bank_mask:0xf
v_dot2c_f32_bf16_dpp v12, v38, v82 row_newbcast:2 row_mask:0xf bank_mask:0xf
v_dot2c_f32_bf16_dpp v13, v39, v82 row_newbcast:2 row_mask:0xf bank_mask:0xf
v_dot2c_f32_bf16_dpp v14, v38, v83 row_newbcast:2 row_mask:0xf bank_mask:0xf
v_dot2c_f32_bf16_dpp v15, v39, v83 row_newbcast:2 row_mask:0xf bank_mask:0xf
s_waitcnt vmcnt(4)
buffer_load_dwordx4 v[104:107], v3, s[12:15], s32 offen nt
s_add_u32 s32, s32, 1024
v_dot2c_f32_bf16_dpp v8, v38, v84 row_newbcast:10 row_mask:0xf bank_mask:0xf
v_dot2c_f32_bf16_dpp v9, v39, v84 row_newbcast:10 row_mask:0xf bank_mask:0xf
v_dot2c_f32_bf16_dpp v10, v38, v85 row_newbcast:10 row_mask:0xf bank_mask:0xf
v_dot2c_f32_bf16_dpp v11, v39, v85 row_newbcast:10 row_mask:0xf bank_mask:0xf
v_dot2c_f32_bf16_dpp v12, v38, v86 row_newbcast:10 row_mask:0xf bank_mask:0xf
v_dot2c_f32_bf16_dpp v13, v39, v86 row_newbcast:10 row_mask:0xf bank_mask:0xf
v_dot2c_f32_bf16_dpp v14, v38, v87 row_newbcast:10 row_mask:0xf bank_mask:0xf
v_dot2c_f32_bf16_dpp v15, v39, v87 row_newbcast:10 row_mask:0xf bank_mask:0xf
s_waitcnt vmcnt(4)
buffer_load_dwordx4 v[108:111], v3, s[12:15], s32 offen nt
s_add_u32 s32, s32, 7168
v_dot2c_f32_bf16_dpp v8, v38, v88 row_newbcast:6 row_mask:0xf bank_mask:0xf
v_dot2c_f32_bf16_dpp v9, v39, v88 row_newbcast:6 row_mask:0xf bank_mask:0xf
v_dot2c_f32_bf16_dpp v10, v38, v89 row_newbcast:6 row_mask:0xf bank_mask:0xf
v_dot2c_f32_bf16_dpp v11, v39, v89 row_newbcast:6 row_mask:0xf bank_mask:0xf
v_dot2c_f32_bf16_dpp v12, v38, v90 row_newbcast:6 row_mask:0xf bank_mask:0xf
v_dot2c_f32_bf16_dpp v13, v39, v90 row_newbcast:6 row_mask:0xf bank_mask:0xf
v_dot2c_f32_bf16_dpp v14, v38, v91 row_newbcast:6 row_mask:0xf bank_mask:0xf
v_dot2c_f32_bf16_dpp v15, v39, v91 row_newbcast:6 row_mask:0xf bank_mask:0xf
s_waitcnt vmcnt(4)
buffer_load_dwordx4 v[112:115], v3, s[12:15], s32 offen nt
s_add_u32 s32, s32, 1024
v_dot2c_f32_bf16_dpp v8, v38, v92 row_newbcast:14 row_mask:0xf bank_mask:0xf
v_dot2c_f32_bf16_dpp v9, v39, v92 row_newbcast:14 row_mask:0xf bank_mask:0xf
v_dot2c_f32_bf16_dpp v10, v38, v93 row_newbcast:14 row_mask:0xf bank_mask:0xf
v_dot2c_f32_bf16_dpp v11, v39, v93 row_newbcast:14 row_mask:0xf bank_mask:0xf
v_dot2c_f32_bf16_dpp v12, v38, v94 row_newbcast:14 row_mask:0xf bank_mask:0xf
v_dot2c_f32_bf16_dpp v13, v39, v94 row_newbcast:14 row_mask:0xf bank_mask:0xf
v_dot2c_f32_bf16_dpp v14, v38, v95 row_newbcast:14 row_mask:0xf bank_mask:0xf
v_dot2c_f32_bf16_dpp v15, v39, v95 row_newbcast:14 row_mask:0xf bank_mask:0xf
s_waitcnt vmcnt(4)
buffer_load_dwordx4 v[116:119], v3, s[12:15], s32 offen nt
s_add_u32 s32, s32, 7168
v_dot2c_f32_bf16_dpp v8, v38, v96 row_newbcast:1 row_mask:0xf bank_mask:0xf
v_dot2c_f32_bf16_dpp v9, v39, v96 row_newbcast:1 row_mask:0xf bank_mask:0xf
v_dot2c_f32_bf16_dpp v10, v38, v97 row_newbcast:1 row_mask:0xf bank_mask:0xf
v_dot2c_f32_bf16_dpp v11, v39, v97 row_newbcast:1 row_mask:0xf bank_mask:0xf
v_dot2c_f32_bf16_dpp v12, v38, v98 row_newbcast:1 row_mask:0xf bank_mask:0xf
v_dot2c_f32_bf16_dpp v13, v39, v98 row_newbcast:1 row_mask:0xf bank_mask:0xf
v_dot2c_f32_bf16_dpp v14, v38, v99 row_newbcast:1 row_mask:0xf bank_mask:0xf
v_dot2c_f32_bf16_dpp v15, v39, v99 row_newbcast:1 row_mask:0xf bank_mask:0xf
s_waitcnt vmcnt(4)
buffer_load_dwordx4 v[120:123], v3, s[12:15], s32 offen nt
s_add_u32 s32, s32, 1024
v_dot2c_f32_bf16_dpp v8, v38, v100 row_newbcast:9 row_mask:0xf bank_mask:0xf
v_dot2c_f32_bf16_dpp v9, v39, v100 row_newbcast:9 row_mask:0xf bank_mask:0xf
v_dot2c_f32_bf16_dpp v10, v38, v101 row_newbcast:9 row_mask:0xf bank_mask:0xf
v_dot2c_f32_bf16_dpp v11, v39, v101 row_newbcast:9 row_mask:0xf bank_mask:0xf
v_dot2c_f32_bf16_dpp v12, v38, v102 row_newbcast:9 row_mask:0xf bank_mask:0xf
v_dot2c_f32_bf16_dpp v13, v39, v102 row_newbcast:9 row_mask:0xf bank_mask:0xf
v_dot2c_f32_bf16_dpp v14, v38, v103 row_newbcast:9 row_mask:0xf bank_mask:0xf
v_dot2c_f32_bf16_dpp v15, v39, v103 row_newbcast:9 row_mask:0xf bank_mask:0xf
s_waitcnt vmcnt(4)
buffer_load_dwordx4 v[124:127], v3, s[12:15], s32 offen nt
s_add_u32 s32, s32, 72704
v_dot2c_f32_bf16_dpp v8, v38, v104 row_newbcast:5 row_mask:0xf bank_mask:0xf
v_dot2c_f32_bf16_dpp v9, v39, v104 row_newbcast:5 row_mask:0xf bank_mask:0xf
v_dot2c_f32_bf16_dpp v10, v38, v105 row_newbcast:5 row_mask:0xf bank_mask:0xf
v_dot2c_f32_bf16_dpp v11, v39, v105 row_newbcast:5 row_mask:0xf bank_mask:0xf
v_dot2c_f32_bf16_dpp v12, v38, v106 row_newbcast:5 row_mask:0xf bank_mask:0xf
v_dot2c_f32_bf16_dpp v13, v39, v106 row_newbcast:5 row_mask:0xf bank_mask:0xf
v_dot2c_f32_bf16_dpp v14, v38, v107 row_newbcast:5 row_mask:0xf bank_mask:0xf
v_dot2c_f32_bf16_dpp v15, v39, v107 row_newbcast:5 row_mask:0xf bank_mask:0xf
s_waitcnt vmcnt(4)
buffer_load_dwordx4 v[64:67], v3, s[12:15], s32 offen nt
s_add_u32 s32, s32, 1024
v_dot2c_f32_bf16_dpp v8, v38, v108 row_newbcast:13 row_mask:0xf bank_mask:0xf
v_dot2c_f32_bf16_dpp v9, v39, v108 row_newbcast:13 row_mask:0xf bank_mask:0xf
v_dot2c_f32_bf16_dpp v10, v38, v109 row_newbcast:13 row_mask:0xf bank_mask:0xf
v_dot2c_f32_bf16_dpp v11, v39, v109 row_newbcast:13 row_mask:0xf bank_mask:0xf
v_dot2c_f32_bf16_dpp v12, v38, v110 row_newbcast:13 row_mask:0xf bank_mask:0xf
v_dot2c_f32_bf16_dpp v13, v39, v110 row_newbcast:13 row_mask:0xf bank_mask:0xf
v_dot2c_f32_bf16_dpp v14, v38, v111 row_newbcast:13 row_mask:0xf bank_mask:0xf
v_dot2c_f32_bf16_dpp v15, v39, v111 row_newbcast:13 row_mask:0xf bank_mask:0xf
s_waitcnt vmcnt(4)
buffer_load_dwordx4 v[68:71], v3, s[12:15], s32 offen nt
s_add_u32 s32, s32, 7168
v_dot2c_f32_bf16_dpp v8, v38, v112 row_newbcast:3 row_mask:0xf bank_mask:0xf
v_dot2c_f32_bf16_dpp v9, v39, v112 row_newbcast:3 row_mask:0xf bank_mask:0xf
v_dot2c_f32_bf16_dpp v10, v38, v113 row_newbcast:3 row_mask:0xf bank_mask:0xf
v_dot2c_f32_bf16_dpp v11, v39, v113 row_newbcast:3 row_mask:0xf bank_mask:0xf
v_dot2c_f32_bf16_dpp v12, v38, v114 row_newbcast:3 row_mask:0xf bank_mask:0xf
v_dot2c_f32_bf16_dpp v13, v39, v114 row_newbcast:3 row_mask:0xf bank_mask:0xf
v_dot2c_f32_bf16_dpp v14, v38, v115 row_newbcast:3 row_mask:0xf bank_mask:0xf
v_dot2c_f32_bf16_dpp v15, v39, v115 row_newbcast:3 row_mask:0xf bank_mask:0xf
s_waitcnt vmcnt(4)
buffer_load_dwordx4 v[72:75], v3, s[12:15], s32 offen nt
s_add_u32 s32, s32, 1024
v_dot2c_f32_bf16_dpp v8, v38, v116 row_newbcast:11 row_mask:0xf bank_mask:0xf
v_dot2c_f32_bf16_dpp v9, v39, v116 row_newbcast:11 row_mask:0xf bank_mask:0xf
v_dot2c_f32_bf16_dpp v10, v38, v117 row_newbcast:11 row_mask:0xf bank_mask:0xf
v_dot2c_f32_bf16_dpp v11, v39, v117 row_newbcast:11 row_mask:0xf bank_mask:0xf
v_dot2c_f32_bf16_dpp v12, v38, v118 row_newbcast:11 row_mask:0xf bank_mask:0xf
v_dot2c_f32_bf16_dpp v13, v39, v118 row_newbcast:11 row_mask:0xf bank_mask:0xf
v_dot2c_f32_bf16_dpp v14, v38, v119 row_newbcast:11 row_mask:0xf bank_mask:0xf
v_dot2c_f32_bf16_dpp v15, v39, v119 row_newbcast:11 row_mask:0xf bank_mask:0xf
s_waitcnt vmcnt(4)
buffer_load_dwordx4 v[76:79], v3, s[12:15], s32 offen nt
s_add_u32 s32, s32, 7168
v_dot2c_f32_bf16_dpp v8, v38, v120 row_newbcast:7 row_mask:0xf bank_mask:0xf
v_dot2c_f32_bf16_dpp v9, v39, v120 row_newbcast:7 row_mask:0xf bank_mask:0xf
v_dot2c_f32_bf16_dpp v10, v38, v121 row_newbcast:7 row_mask:0xf bank_mask:0xf
v_dot2c_f32_bf16_dpp v11, v39, v121 row_newbcast:7 row_mask:0xf bank_mask:0xf
v_dot2c_f32_bf16_dpp v12, v38, v122 row_newbcast:7 row_mask:0xf bank_mask:0xf
v_dot2c_f32_bf16_dpp v13, v39, v122 row_newbcast:7 row_mask:0xf bank_mask:0xf
v_dot2c_f32_bf16_dpp v14, v38, v123 row_newbcast:7 row_mask:0xf bank_mask:0xf
v_dot2c_f32_bf16_dpp v15, v39, v123 row_newbcast:7 row_mask:0xf bank_mask:0xf
s_waitcnt vmcnt(4)
buffer_load_dwordx4 v[80:83], v3, s[12:15], s32 offen nt
s_add_u32 s32, s32, 1024
v_dot2c_f32_bf16_dpp v8, v38, v124 row_newbcast:15 row_mask:0xf bank_mask:0xf
v_dot2c_f32_bf16_dpp v9, v39, v124 row_newbcast:15 row_mask:0xf bank_mask:0xf
v_dot2c_f32_bf16_dpp v10, v38, v125 row_newbcast:15 row_mask:0xf bank_mask:0xf
v_dot2c_f32_bf16_dpp v11, v39, v125 row_newbcast:15 row_mask:0xf bank_mask:0xf
v_dot2c_f32_bf16_dpp v12, v38, v126 row_newbcast:15 row_mask:0xf bank_mask:0xf
v_dot2c_f32_bf16_dpp v13, v39, v126 row_newbcast:15 row_mask:0xf bank_mask:0xf
v_dot2c_f32_bf16_dpp v14, v38, v127 row_newbcast:15 row_mask:0xf bank_mask:0xf
v_dot2c_f32_bf16_dpp v15, v39, v127 row_newbcast:15 row_mask:0xf bank_mask:0xf
s_waitcnt lgkmcnt(0)
s_add_u32 s33, s33, 1
s_cmp_lt_u32 s33, 15
s_cbranch_scc1 L_vloop
v_and_b32 v40, 15, v2
v_lshlrev_b32 v40, 4, v40
v_lshrrev_b32 v41, 4, v2
v_lshlrev_b32 v41, 2, v41
v_add_u32 v40, v40, v41
s_lshl_b32 s58, s3, 8
s_add_u32 s58, s58, 2048
v_add_u32 v40, s58, v40
s_lshl_b32 s58, s3, 2
s_add_u32 s58, s58, 4128
v_mov_b32 v42, s58
s_and_b32 s58, s2, 7
s_lshl_b32 s58, s58, 2
s_add_u32 s58, s58, 32
v_mov_b32 v44, s58
v_mov_b32 v46, 1
s_mov_b32 s63, 262144
L_fwspin:
ds_read_b32 v43, v42
s_waitcnt lgkmcnt(0)
v_cmp_eq_u32 vcc, -1, v43
s_cbranch_vccz L_fwok
s_sub_u32 s63, s63, 1
s_cbranch_scc0 L_fwspin
L_fwok:
buffer_load_dwordx4 v[84:87], v3, s[12:15], s32 offen nt
s_add_u32 s32, s32, 7168
buffer_load_dwordx4 v[88:91], v3, s[12:15], s32 offen nt
s_add_u32 s32, s32, 1024
buffer_load_dwordx4 v[92:95], v3, s[12:15], s32 offen nt
s_add_u32 s32, s32, 7168
buffer_load_dwordx4 v[96:99], v3, s[12:15], s32 offen nt
s_add_u32 s32, s32, 1024
buffer_load_dwordx4 v[100:103], v3, s[12:15], s32 offen nt
s_add_u32 s32, s32, 7168
buffer_load_dwordx4 v[104:107], v3, s[12:15], s32 offen nt
s_add_u32 s32, s32, 1024
buffer_load_dwordx4 v[108:111], v3, s[12:15], s32 offen nt
s_add_u32 s32, s32, 7168
buffer_load_dwordx4 v[112:115], v3, s[12:15], s32 offen nt
s_add_u32 s32, s32, 1024
buffer_load_dwordx4 v[116:119], v3, s[12:15], s32 offen nt
s_add_u32 s32, s32, 7168
buffer_load_dwordx4 v[120:123], v3, s[12:15], s32 offen nt
s_add_u32 s32, s32, 1024
buffer_load_dwordx4 v[124:127], v3, s[12:15], s32 offen nt
s_add_u32 s32, s32, 72704
v_and_b32 v38, 0xffff, v37
v_and_b32 v39, 0xffff0000, v37
s_waitcnt vmcnt(15)
v_dot2c_f32_bf16_dpp v8, v38, v64 row_newbcast:0 row_mask:0xf bank_mask:0xf
v_dot2c_f32_bf16_dpp v9, v39, v64 row_newbcast:0 row_mask:0xf bank_mask:0xf
v_dot2c_f32_bf16_dpp v10, v38, v65 row_newbcast:0 row_mask:0xf bank_mask:0xf
v_dot2c_f32_bf16_dpp v11, v39, v65 row_newbcast:0 row_mask:0xf bank_mask:0xf
v_dot2c_f32_bf16_dpp v12, v38, v66 row_newbcast:0 row_mask:0xf bank_mask:0xf
v_dot2c_f32_bf16_dpp v13, v39, v66 row_newbcast:0 row_mask:0xf bank_mask:0xf
v_dot2c_f32_bf16_dpp v14, v38, v67 row_newbcast:0 row_mask:0xf bank_mask:0xf
v_dot2c_f32_bf16_dpp v15, v39, v67 row_newbcast:0 row_mask:0xf bank_mask:0xf
s_waitcnt vmcnt(14)
v_dot2c_f32_bf16_dpp v8, v38, v68 row_newbcast:8 row_mask:0xf bank_mask:0xf
v_dot2c_f32_bf16_dpp v9, v39, v68 row_newbcast:8 row_mask:0xf bank_mask:0xf
v_dot2c_f32_bf16_dpp v10, v38, v69 row_newbcast:8 row_mask:0xf bank_mask:0xf
v_dot2c_f32_bf16_dpp v11, v39, v69 row_newbcast:8 row_mask:0xf bank_mask:0xf
v_dot2c_f32_bf16_dpp v12, v38, v70 row_newbcast:8 row_mask:0xf bank_mask:0xf
v_dot2c_f32_bf16_dpp v13, v39, v70 row_newbcast:8 row_mask:0xf bank_mask:0xf
v_dot2c_f32_bf16_dpp v14, v38, v71 row_newbcast:8 row_mask:0xf bank_mask:0xf
v_dot2c_f32_bf16_dpp v15, v39, v71 row_newbcast:8 row_mask:0xf bank_mask:0xf
s_waitcnt vmcnt(13)
v_dot2c_f32_bf16_dpp v8, v38, v72 row_newbcast:4 row_mask:0xf bank_mask:0xf
v_dot2c_f32_bf16_dpp v9, v39, v72 row_newbcast:4 row_mask:0xf bank_mask:0xf
v_dot2c_f32_bf16_dpp v10, v38, v73 row_newbcast:4 row_mask:0xf bank_mask:0xf
v_dot2c_f32_bf16_dpp v11, v39, v73 row_newbcast:4 row_mask:0xf bank_mask:0xf
v_dot2c_f32_bf16_dpp v12, v38, v74 row_newbcast:4 row_mask:0xf bank_mask:0xf
v_dot2c_f32_bf16_dpp v13, v39, v74 row_newbcast:4 row_mask:0xf bank_mask:0xf
v_dot2c_f32_bf16_dpp v14, v38, v75 row_newbcast:4 row_mask:0xf bank_mask:0xf
v_dot2c_f32_bf16_dpp v15, v39, v75 row_newbcast:4 row_mask:0xf bank_mask:0xf
s_waitcnt vmcnt(12)
v_dot2c_f32_bf16_dpp v8, v38, v76 row_newbcast:12 row_mask:0xf bank_mask:0xf
v_dot2c_f32_bf16_dpp v9, v39, v76 row_newbcast:12 row_mask:0xf bank_mask:0xf
v_dot2c_f32_bf16_dpp v10, v38, v77 row_newbcast:12 row_mask:0xf bank_mask:0xf
v_dot2c_f32_bf16_dpp v11, v39, v77 row_newbcast:12 row_mask:0xf bank_mask:0xf
v_dot2c_f32_bf16_dpp v12, v38, v78 row_newbcast:12 row_mask:0xf bank_mask:0xf
v_dot2c_f32_bf16_dpp v13, v39, v78 row_newbcast:12 row_mask:0xf bank_mask:0xf
v_dot2c_f32_bf16_dpp v14, v38, v79 row_newbcast:12 row_mask:0xf bank_mask:0xf
v_dot2c_f32_bf16_dpp v15, v39, v79 row_newbcast:12 row_mask:0xf bank_mask:0xf
s_waitcnt vmcnt(11)
v_dot2c_f32_bf16_dpp v8, v38, v80 row_newbcast:2 row_mask:0xf bank_mask:0xf
v_dot2c_f32_bf16_dpp v9, v39, v80 row_newbcast:2 row_mask:0xf bank_mask:0xf
v_dot2c_f32_bf16_dpp v10, v38, v81 row_newbcast:2 row_mask:0xf bank_mask:0xf
v_dot2c_f32_bf16_dpp v11, v39, v81 row_newbcast:2 row_mask:0xf bank_mask:0xf
v_dot2c_f32_bf16_dpp v12, v38, v82 row_newbcast:2 row_mask:0xf bank_mask:0xf
v_dot2c_f32_bf16_dpp v13, v39, v82 row_newbcast:2 row_mask:0xf bank_mask:0xf
v_dot2c_f32_bf16_dpp v14, v38, v83 row_newbcast:2 row_mask:0xf bank_mask:0xf
v_dot2c_f32_bf16_dpp v15, v39, v83 row_newbcast:2 row_mask:0xf bank_mask:0xf
s_waitcnt vmcnt(10)
v_dot2c_f32_bf16_dpp v8, v38, v84 row_newbcast:10 row_mask:0xf bank_mask:0xf
v_dot2c_f32_bf16_dpp v9, v39, v84 row_newbcast:10 row_mask:0xf bank_mask:0xf
v_dot2c_f32_bf16_dpp v10, v38, v85 row_newbcast:10 row_mask:0xf bank_mask:0xf
v_dot2c_f32_bf16_dpp v11, v39, v85 row_newbcast:10 row_mask:0xf bank_mask:0xf
v_dot2c_f32_bf16_dpp v12, v38, v86 row_newbcast:10 row_mask:0xf bank_mask:0xf
v_dot2c_f32_bf16_dpp v13, v39, v86 row_newbcast:10 row_mask:0xf bank_mask:0xf
v_dot2c_f32_bf16_dpp v14, v38, v87 row_newbcast:10 row_mask:0xf bank_mask:0xf
v_dot2c_f32_bf16_dpp v15, v39, v87 row_newbcast:10 row_mask:0xf bank_mask:0xf
s_waitcnt vmcnt(9)
v_dot2c_f32_bf16_dpp v8, v38, v88 row_newbcast:6 row_mask:0xf bank_mask:0xf
v_dot2c_f32_bf16_dpp v9, v39, v88 row_newbcast:6 row_mask:0xf bank_mask:0xf
v_dot2c_f32_bf16_dpp v10, v38, v89 row_newbcast:6 row_mask:0xf bank_mask:0xf
v_dot2c_f32_bf16_dpp v11, v39, v89 row_newbcast:6 row_mask:0xf bank_mask:0xf
v_dot2c_f32_bf16_dpp v12, v38, v90 row_newbcast:6 row_mask:0xf bank_mask:0xf
v_dot2c_f32_bf16_dpp v13, v39, v90 row_newbcast:6 row_mask:0xf bank_mask:0xf
v_dot2c_f32_bf16_dpp v14, v38, v91 row_newbcast:6 row_mask:0xf bank_mask:0xf
v_dot2c_f32_bf16_dpp v15, v39, v91 row_newbcast:6 row_mask:0xf bank_mask:0xf
s_waitcnt vmcnt(8)
v_dot2c_f32_bf16_dpp v8, v38, v92 row_newbcast:14 row_mask:0xf bank_mask:0xf
v_dot2c_f32_bf16_dpp v9, v39, v92 row_newbcast:14 row_mask:0xf bank_mask:0xf
v_dot2c_f32_bf16_dpp v10, v38, v93 row_newbcast:14 row_mask:0xf bank_mask:0xf
v_dot2c_f32_bf16_dpp v11, v39, v93 row_newbcast:14 row_mask:0xf bank_mask:0xf
v_dot2c_f32_bf16_dpp v12, v38, v94 row_newbcast:14 row_mask:0xf bank_mask:0xf
v_dot2c_f32_bf16_dpp v13, v39, v94 row_newbcast:14 row_mask:0xf bank_mask:0xf
v_dot2c_f32_bf16_dpp v14, v38, v95 row_newbcast:14 row_mask:0xf bank_mask:0xf
v_dot2c_f32_bf16_dpp v15, v39, v95 row_newbcast:14 row_mask:0xf bank_mask:0xf
s_waitcnt vmcnt(7)
v_dot2c_f32_bf16_dpp v8, v38, v96 row_newbcast:1 row_mask:0xf bank_mask:0xf
v_dot2c_f32_bf16_dpp v9, v39, v96 row_newbcast:1 row_mask:0xf bank_mask:0xf
v_dot2c_f32_bf16_dpp v10, v38, v97 row_newbcast:1 row_mask:0xf bank_mask:0xf
v_dot2c_f32_bf16_dpp v11, v39, v97 row_newbcast:1 row_mask:0xf bank_mask:0xf
v_dot2c_f32_bf16_dpp v12, v38, v98 row_newbcast:1 row_mask:0xf bank_mask:0xf
v_dot2c_f32_bf16_dpp v13, v39, v98 row_newbcast:1 row_mask:0xf bank_mask:0xf
v_dot2c_f32_bf16_dpp v14, v38, v99 row_newbcast:1 row_mask:0xf bank_mask:0xf
v_dot2c_f32_bf16_dpp v15, v39, v99 row_newbcast:1 row_mask:0xf bank_mask:0xf
s_waitcnt vmcnt(6)
v_dot2c_f32_bf16_dpp v8, v38, v100 row_newbcast:9 row_mask:0xf bank_mask:0xf
v_dot2c_f32_bf16_dpp v9, v39, v100 row_newbcast:9 row_mask:0xf bank_mask:0xf
v_dot2c_f32_bf16_dpp v10, v38, v101 row_newbcast:9 row_mask:0xf bank_mask:0xf
v_dot2c_f32_bf16_dpp v11, v39, v101 row_newbcast:9 row_mask:0xf bank_mask:0xf
v_dot2c_f32_bf16_dpp v12, v38, v102 row_newbcast:9 row_mask:0xf bank_mask:0xf
v_dot2c_f32_bf16_dpp v13, v39, v102 row_newbcast:9 row_mask:0xf bank_mask:0xf
v_dot2c_f32_bf16_dpp v14, v38, v103 row_newbcast:9 row_mask:0xf bank_mask:0xf
v_dot2c_f32_bf16_dpp v15, v39, v103 row_newbcast:9 row_mask:0xf bank_mask:0xf
s_waitcnt vmcnt(5)
v_dot2c_f32_bf16_dpp v8, v38, v104 row_newbcast:5 row_mask:0xf bank_mask:0xf
v_dot2c_f32_bf16_dpp v9, v39, v104 row_newbcast:5 row_mask:0xf bank_mask:0xf
v_dot2c_f32_bf16_dpp v10, v38, v105 row_newbcast:5 row_mask:0xf bank_mask:0xf
v_dot2c_f32_bf16_dpp v11, v39, v105 row_newbcast:5 row_mask:0xf bank_mask:0xf
v_dot2c_f32_bf16_dpp v12, v38, v106 row_newbcast:5 row_mask:0xf bank_mask:0xf
v_dot2c_f32_bf16_dpp v13, v39, v106 row_newbcast:5 row_mask:0xf bank_mask:0xf
v_dot2c_f32_bf16_dpp v14, v38, v107 row_newbcast:5 row_mask:0xf bank_mask:0xf
v_dot2c_f32_bf16_dpp v15, v39, v107 row_newbcast:5 row_mask:0xf bank_mask:0xf
s_waitcnt vmcnt(4)
v_dot2c_f32_bf16_dpp v8, v38, v108 row_newbcast:13 row_mask:0xf bank_mask:0xf
v_dot2c_f32_bf16_dpp v9, v39, v108 row_newbcast:13 row_mask:0xf bank_mask:0xf
v_dot2c_f32_bf16_dpp v10, v38, v109 row_newbcast:13 row_mask:0xf bank_mask:0xf
v_dot2c_f32_bf16_dpp v11, v39, v109 row_newbcast:13 row_mask:0xf bank_mask:0xf
v_dot2c_f32_bf16_dpp v12, v38, v110 row_newbcast:13 row_mask:0xf bank_mask:0xf
v_dot2c_f32_bf16_dpp v13, v39, v110 row_newbcast:13 row_mask:0xf bank_mask:0xf
v_dot2c_f32_bf16_dpp v14, v38, v111 row_newbcast:13 row_mask:0xf bank_mask:0xf
v_dot2c_f32_bf16_dpp v15, v39, v111 row_newbcast:13 row_mask:0xf bank_mask:0xf
s_waitcnt vmcnt(3)
v_dot2c_f32_bf16_dpp v8, v38, v112 row_newbcast:3 row_mask:0xf bank_mask:0xf
v_dot2c_f32_bf16_dpp v9, v39, v112 row_newbcast:3 row_mask:0xf bank_mask:0xf
v_dot2c_f32_bf16_dpp v10, v38, v113 row_newbcast:3 row_mask:0xf bank_mask:0xf
v_dot2c_f32_bf16_dpp v11, v39, v113 row_newbcast:3 row_mask:0xf bank_mask:0xf
v_dot2c_f32_bf16_dpp v12, v38, v114 row_newbcast:3 row_mask:0xf bank_mask:0xf
v_dot2c_f32_bf16_dpp v13, v39, v114 row_newbcast:3 row_mask:0xf bank_mask:0xf
v_dot2c_f32_bf16_dpp v14, v38, v115 row_newbcast:3 row_mask:0xf bank_mask:0xf
v_dot2c_f32_bf16_dpp v15, v39, v115 row_newbcast:3 row_mask:0xf bank_mask:0xf
s_waitcnt vmcnt(2)
v_dot2c_f32_bf16_dpp v8, v38, v116 row_newbcast:11 row_mask:0xf bank_mask:0xf
v_dot2c_f32_bf16_dpp v9, v39, v116 row_newbcast:11 row_mask:0xf bank_mask:0xf
v_dot2c_f32_bf16_dpp v10, v38, v117 row_newbcast:11 row_mask:0xf bank_mask:0xf
v_dot2c_f32_bf16_dpp v11, v39, v117 row_newbcast:11 row_mask:0xf bank_mask:0xf
v_dot2c_f32_bf16_dpp v12, v38, v118 row_newbcast:11 row_mask:0xf bank_mask:0xf
v_dot2c_f32_bf16_dpp v13, v39, v118 row_newbcast:11 row_mask:0xf bank_mask:0xf
v_dot2c_f32_bf16_dpp v14, v38, v119 row_newbcast:11 row_mask:0xf bank_mask:0xf
v_dot2c_f32_bf16_dpp v15, v39, v119 row_newbcast:11 row_mask:0xf bank_mask:0xf
s_waitcnt vmcnt(1)
v_dot2c_f32_bf16_dpp v8, v38, v120 row_newbcast:7 row_mask:0xf bank_mask:0xf
v_dot2c_f32_bf16_dpp v9, v39, v120 row_newbcast:7 row_mask:0xf bank_mask:0xf
v_dot2c_f32_bf16_dpp v10, v38, v121 row_newbcast:7 row_mask:0xf bank_mask:0xf
v_dot2c_f32_bf16_dpp v11, v39, v121 row_newbcast:7 row_mask:0xf bank_mask:0xf
v_dot2c_f32_bf16_dpp v12, v38, v122 row_newbcast:7 row_mask:0xf bank_mask:0xf
v_dot2c_f32_bf16_dpp v13, v39, v122 row_newbcast:7 row_mask:0xf bank_mask:0xf
v_dot2c_f32_bf16_dpp v14, v38, v123 row_newbcast:7 row_mask:0xf bank_mask:0xf
v_dot2c_f32_bf16_dpp v15, v39, v123 row_newbcast:7 row_mask:0xf bank_mask:0xf
s_waitcnt vmcnt(0)
v_dot2c_f32_bf16_dpp v8, v38, v124 row_newbcast:15 row_mask:0xf bank_mask:0xf
v_dot2c_f32_bf16_dpp v9, v39, v124 row_newbcast:15 row_mask:0xf bank_mask:0xf
v_dot2c_f32_bf16_dpp v10, v38, v125 row_newbcast:15 row_mask:0xf bank_mask:0xf
v_dot2c_f32_bf16_dpp v11, v39, v125 row_newbcast:15 row_mask:0xf bank_mask:0xf
v_dot2c_f32_bf16_dpp v12, v38, v126 row_newbcast:15 row_mask:0xf bank_mask:0xf
v_dot2c_f32_bf16_dpp v13, v39, v126 row_newbcast:15 row_mask:0xf bank_mask:0xf
v_dot2c_f32_bf16_dpp v14, v38, v127 row_newbcast:15 row_mask:0xf bank_mask:0xf
v_dot2c_f32_bf16_dpp v15, v39, v127 row_newbcast:15 row_mask:0xf bank_mask:0xf
s_cmp_lg_u32 s3, 0
s_cbranch_scc1 L_notick
s_mov_b64 exec, 1
global_atomic_add v45, v44, v46, s[54:55] sc0
s_mov_b64 exec, -1
L_notick:
v_permlane32_swap_b32 v8, v12
v_permlane32_swap_b32 v9, v13
v_permlane32_swap_b32 v10, v14
v_permlane32_swap_b32 v11, v15
v_add_f32 v8, v8, v12
v_add_f32 v9, v9, v13
v_add_f32 v10, v10, v14
v_add_f32 v11, v11, v15
s_nop 0
v_permlane16_swap_b32 v8, v10
v_permlane16_swap_b32 v9, v11
v_add_f32 v8, v8, v10
v_add_f32 v9, v9, v11
v_mul_f32 v8, v8, v43
v_mul_f32 v9, v9, v43
v_cvt_pk_bf16_f32 v8, v8, v9
ds_write_b32 v40, v8
s_waitcnt lgkmcnt(0)
s_barrier
s_waitcnt vmcnt(0)
s_cmp_lg_u32 s3, 0
s_cbranch_scc1 L_norole
v_readfirstlane_b32 s58, v45
s_and_b32 s59, s2, 7
s_lshl_b32 s60, s58, 3
s_add_u32 s60, s60, s59
s_mov_b32 s88, 255
s_sub_u32 s61, s60, 120
s_cmp_lt_u32 s58, 23
s_cselect_b32 s88, s61, s88
s_add_u32 s61, s60, 32
s_cmp_lt_u32 s58, 15
s_cselect_b32 s88, s61, s88
s_add_u32 s61, s60, 152
s_cmp_lt_u32 s58, 4
s_cselect_b32 s88, s61, s88
s_cmp_ge_u32 s88, 184
s_cbranch_scc1 L_inok2
v_and_b32 v46, 1, v2
v_mul_u32_u24 v46, 6721536, v46
s_mov_b32 s59, 618496
buffer_load_dword v47, v46, s[16:19], s59 offen sc1
s_bfe_u32 s59, s2, 0x20003
s_lshl_b32 s59, s59, 10
s_add_u32 s59, s59, 663552
v_lshlrev_b32 v46, 4, v2
s_mov_b32 s63, 262144
L_inspin2:
buffer_load_dwordx4 v[48:51], v46, s[16:19], s59 offen sc1
s_waitcnt vmcnt(0)
v_readlane_b32 s60, v47, 0
v_readlane_b32 s61, v47, 1
s_nop 0
s_mul_i32 s61, s61, 3
s_add_u32 s60, s60, s61
s_add_u32 s60, s60, 4
v_mov_b32 v52, s60
v_xor_b32 v48, v52, v48
v_xor_b32 v49, v52, v49
v_xor_b32 v50, v52, v50
v_xor_b32 v51, v52, v51
v_or3_b32 v48, v48, v49, v50
v_or_b32 v48, v48, v51
v_cmp_ne_u32 vcc, 0, v48
s_cbranch_vccz L_inok2
s_sleep 2
s_sub_u32 s63, s63, 1
s_cbranch_scc0 L_inspin2
L_inok2:
v_mov_b32 v44, 4168
v_mov_b32 v45, s88
s_mov_b64 exec, 1
ds_write_b32 v44, v45
s_mov_b64 exec, -1
s_waitcnt lgkmcnt(0)
L_norole:
s_barrier
v_mov_b32 v44, 4168
ds_read_b32 v45, v44
s_waitcnt lgkmcnt(0)
v_readfirstlane_b32 s88, v45
s_nop 0
s_cmp_lt_u32 s88, 64
s_cbranch_scc1 L_red
s_cmp_lt_u32 s88, 152
s_cbranch_scc1 L_ffn1
s_cmp_lt_u32 s88, 184
s_cbranch_scc1 L_ffn2
L_sdone:
s_endpgm
L_red:
s_lshl_b32 s58, s88, 13
s_lshl_b32 s59, s3, 11
s_add_u32 s58, s58, s59
v_lshlrev_b32 v3, 4, v2
s_lshr_b32 s61, s88, 4
s_lshl_b32 s59, s61, 10
s_and_b32 s60, s88, 15
s_lshl_b32 s33, s60, 6
s_add_u32 s59, s59, s33
v_and_b32 v4, 7, v2
v_lshlrev_b32 v4, 2, v4
v_lshrrev_b32 v5, 5, v2
v_lshlrev_b32 v5, 5, v5
v_add_u32 v4, v4, v5
s_mov_b32 s20, s36
s_mov_b32 s21, s37
s_mov_b32 s22, 4096
s_mov_b32 s23, 0x20000
buffer_load_dword v6, v4, s[20:23], s59 offen
v_bfe_u32 v5, v2, 3, 2
v_lshlrev_b32 v5, 12, v5
v_add_u32 v7, v4, v5
s_lshl_b32 s60, s60, 8
s_lshl_b32 s61, s61, 6
s_add_u32 s59, s60, s61
s_add_u32 s59, s59, 524288
v_lshlrev_b32 v9, 1, v4
s_lshl_b32 s60, s3, 7
v_add_u32 v10, s60, v9
s_mov_b32 s63, 262144
buffer_load_dwordx4 v[16:19], v3, s[16:19], s58 offen sc1
buffer_load_dwordx4 v[20:23], v3, s[16:19], s58 offen offset:1024 sc1
L_redspin:
s_waitcnt vmcnt(0)
v_max3_u32 v8, v16, v17, v18
v_max3_u32 v11, v20, v21, v22
v_max_u32 v8, v8, v19
v_max_u32 v11, v11, v23
v_cmp_eq_u32 s[80:81], -1, v8
v_cmp_eq_u32 s[82:83], -1, v11
s_nop 0
s_or_b64 s[84:85], s[80:81], s[82:83]
s_cbranch_scc0 L_redok
s_or_b32 s80, s80, 1
s_or_b32 s82, s82, 1
s_mov_b64 exec, s[80:81]
buffer_load_dwordx4 v[16:19], v3, s[16:19], s58 offen sc1
s_mov_b64 exec, s[82:83]
buffer_load_dwordx4 v[20:23], v3, s[16:19], s58 offen offset:1024 sc1
s_mov_b64 exec, -1
s_sub_u32 s63, s63, 1
s_cbranch_scc0 L_redspin
L_redok:
v_add_f32 v24, v16, v20
v_add_f32 v25, v17, v21
v_add_f32 v26, v18, v22
v_add_f32 v27, v19, v23
v_permlane32_swap_b32 v24, v25
s_nop 0
v_permlane32_swap_b32 v26, v27
v_add_f32 v24, v24, v25
v_add_f32 v25, v26, v27
v_mov_b32 v26, v24
v_mov_b32 v27, v25
s_nop 0
v_permlane16_swap_b32 v24, v26
v_permlane16_swap_b32 v25, v27
v_add_f32 v24, v24, v26
v_add_f32 v25, v25, v27
s_nop 0
v_add_f32_dpp v24, v24, v24 row_ror:8 row_mask:0xf bank_mask:0xf
v_add_f32_dpp v25, v25, v25 row_ror:8 row_mask:0xf bank_mask:0xf
ds_write_b64 v10, v[24:25] offset:4352
s_waitcnt lgkmcnt(0)
s_barrier
s_cmp_lg_u32 s3, 0
s_cbranch_scc1 L_sdone
ds_read_b64 v[32:33], v9 offset:4352
ds_read_b64 v[34:35], v9 offset:4480
ds_read_b64 v[36:37], v9 offset:4608
ds_read_b64 v[38:39], v9 offset:4736
v_lshlrev_b32 v40, 16, v6
v_and_b32 v41, 0xffff0000, v6
v_mov_b32 v42, 0x7fc07fc0
s_waitcnt lgkmcnt(0)
v_add_f32 v32, v32, v34
v_add_f32 v33, v33, v35
v_add_f32 v36, v36, v38
v_add_f32 v37, v37, v39
v_add_f32 v32, v32, v36
v_add_f32 v33, v33, v37
v_cvt_pk_bf16_f32 v32, v32, v33
v_lshlrev_b32 v34, 16, v32
v_and_b32 v35, 0xffff0000, v32
v_add_f32 v34, v34, v40
v_add_f32 v35, v35, v41
v_cvt_pk_bf16_f32 v32, v34, v35
v_cmp_eq_u32 vcc, -1, v32
s_nop 1
v_cndmask_b32 v32, v32, v42, vcc
buffer_store_dword v32, v7, s[16:19], s59 offen sc1
s_add_u32 s59, s59, 16384
buffer_store_dword v32, v7, s[16:19], s59 offen sc1
s_add_u32 s59, s59, 16384
s_mov_b32 exec_lo, 0xff
s_mov_b32 exec_hi, 0xff
buffer_store_dword v32, v4, s[16:19], s59 offen sc1
s_mov_b64 exec, -1
s_branch L_sdone
L_ffn1:
s_sub_u32 s58, s88, 64
s_and_b32 s59, s58, 7
s_lshr_b32 s58, s58, 3
s_lshr_b32 s60, s58, 2
s_lshl_b32 s60, s60, 3
s_add_u32 s60, s60, s59
s_lshl_b32 s60, s60, 2
s_and_b32 s61, s58, 3
s_add_u32 s60, s60, s61
s_mul_i32 s59, s59, 3
s_add_u32 s59, s59, s58
s_add_u32 s59, s59, 56
s_cmp_lt_u32 s58, 8
s_cselect_b32 s35, s60, s59
s_cmp_ge_u32 s35, 86
s_cbranch_scc1 L_sdone
v_lshrrev_b32 v14, 1, v2
v_mul_u32_u24 v14, 2752, v14
v_and_b32 v6, 1, v2
v_lshlrev_b32 v6, 4, v6
v_add_u32 v14, v14, v6
s_mul_i32 s58, s3, 352256
v_add_u32 v14, s58, v14
s_lshl_b32 s59, s35, 5
s_add_u32 s20, s48, s59
s_addc_u32 s21, s49, 0
s_sub_u32 s22, 1409024, s59
s_mov_b32 s23, 0x20000
s_mov_b32 s32, 0
buffer_load_dwordx4 v[16:19], v14, s[20:23], s32 offen nt
s_add_u32 s32, s32, 88064
buffer_load_dwordx4 v[20:23], v14, s[20:23], s32 offen nt
s_add_u32 s32, s32, 88064
buffer_load_dwordx4 v[24:27], v14, s[20:23], s32 offen nt
s_add_u32 s32, s32, 88064
buffer_load_dwordx4 v[28:31], v14, s[20:23], s32 offen nt
s_add_u32 s32, s32, 88064
v_lshlrev_b32 v15, 4, v2
s_mul_i32 s58, s3, 12288
s_add_u32 s58, s58, 32768
v_add_u32 v15, s58, v15
v_lshrrev_b32 v4, 4, v2
v_lshlrev_b32 v4, 8, v4
v_bfe_u32 v40, v2, 2, 2
v_lshlrev_b32 v40, 5, v40
v_add_u32 v4, v4, v40
v_and_b32 v40, 3, v2
v_lshlrev_b32 v40, 3, v40
v_add_u32 v4, v4, v40
s_mul_i32 s58, s3, 12288
s_add_u32 s58, s58, 32768
v_add_u32 v4, s58, v4
s_waitcnt vmcnt(0)
ds_write_b128 v15, v[16:19] offset:0
ds_write_b128 v15, v[20:23] offset:1024
ds_write_b128 v15, v[24:27] offset:2048
ds_write_b128 v15, v[28:31] offset:3072
ds_read_b64_tr_b16 v[64:65], v4 offset:0
ds_read_b64_tr_b16 v[66:67], v4 offset:128
ds_read_b64_tr_b16 v[68:69], v4 offset:1024
ds_read_b64_tr_b16 v[70:71], v4 offset:1152
ds_read_b64_tr_b16 v[72:73], v4 offset:2048
ds_read_b64_tr_b16 v[74:75], v4 offset:2176
ds_read_b64_tr_b16 v[76:77], v4 offset:3072
ds_read_b64_tr_b16 v[78:79], v4 offset:3200
v_mov_b32 v80, 0x3f803f80
v_mov_b32 v81, 0x3f803f80
v_mov_b32 v82, 0x3f803f80
v_mov_b32 v83, 0x3f803f80
v_mov_b32 v84, 0
v_mov_b32 v85, 0
v_mov_b32 v86, 0
v_mov_b32 v87, 0
s_waitcnt vmcnt(0) lgkmcnt(0)
s_nop 0
v_mfma_f32_16x16x32_bf16 v[84:87], v[64:67], v[80:83], v[84:87]
v_mfma_f32_16x16x32_bf16 v[84:87], v[68:71], v[80:83], v[84:87]
v_mfma_f32_16x16x32_bf16 v[84:87], v[72:75], v[80:83], v[84:87]
v_mfma_f32_16x16x32_bf16 v[84:87], v[76:79], v[80:83], v[84:87]
v_lshlrev_b32 v5, 4, v2
s_lshl_b32 s58, s3, 10
v_add_u32 v5, s58, v5
v_lshlrev_b32 v6, 3, v2
s_lshl_b32 s58, s3, 9
v_add_u32 v6, s58, v6
s_nop 1
ds_write_b128 v5, v[84:87] offset:10752
s_waitcnt lgkmcnt(0)
s_barrier
v_lshlrev_b32 v7, 4, v2
ds_read_b128 v[16:19], v7 offset:10752
ds_read_b128 v[20:23], v7 offset:11776
ds_read_b128 v[24:27], v7 offset:12800
ds_read_b128 v[28:31], v7 offset:13824
v_and_b32 v8, 15, v2
v_lshlrev_b32 v8, 6, v8
v_lshrrev_b32 v9, 4, v2
v_lshlrev_b32 v9, 4, v9
v_add_u32 v8, v8, v9
s_lshl_b32 s58, s3, 10
v_add_u32 v8, s58, v8
s_waitcnt lgkmcnt(0)
v_add_f32 v16, v16, v20
v_add_f32 v24, v24, v28
v_add_f32 v17, v17, v21
v_add_f32 v25, v25, v29
v_add_f32 v18, v18, v22
v_add_f32 v26, v26, v30
v_add_f32 v19, v19, v23
v_add_f32 v27, v27, v31
v_add_f32 v84, v16, v24
v_add_f32 v85, v17, v25
v_add_f32 v86, v18, v26
v_add_f32 v87, v19, v27
s_and_b32 s58, s88, 7
s_lshl_b32 s58, s58, 12
s_add_u32 s58, s58, 524288
s_mov_b32 s90, 0xf000f0
s_mov_b32 s91, 0xf000f0
s_mov_b32 s92, 0xf000f00
s_mov_b32 s93, 0xf000f00
s_mov_b32 s94, 0xf000f000
s_mov_b32 s95, 0xf000f000
v_and_b32 v12, 3, v2
v_lshlrev_b32 v12, 5, v12
v_lshrrev_b32 v9, 4, v2
v_lshlrev_b32 v9, 3, v9
v_add_u32 v12, v12, v9
v_bfe_u32 v9, v2, 2, 2
v_mul_u32_u24 v9, 11264, v9
v_add_u32 v12, v12, v9
s_lshl_b32 s59, s35, 7
s_add_u32 s59, s59, 565248
v_lshlrev_b32 v6, 2, v2
s_lshl_b32 s60, s3, 8
v_add_u32 v6, s60, v6
v_and_b32 v13, 15, v2
v_lshlrev_b32 v13, 2, v13
s_mov_b32 s63, 262144
L_f1spin:
s_sleep 1
buffer_load_dwordx4 v[16:19], v8, s[16:19], s58 offen sc1
s_waitcnt vmcnt(0)
v_max_u32 v10, v16, v17
v_max3_u32 v10, v10, v18, v19
v_cmp_eq_u32 vcc, -1, v10
s_cbranch_vccz L_f1ok
s_sub_u32 s63, s63, 1
s_cbranch_scc0 L_f1spin
L_f1ok:
v_mfma_f32_16x16x32_bf16 v[88:91], v[64:67], v[16:19], 0
v_mfma_f32_16x16x32_bf16 v[92:95], v[68:71], v[16:19], 0
v_mfma_f32_16x16x32_bf16 v[96:99], v[72:75], v[16:19], 0
v_mfma_f32_16x16x32_bf16 v[100:103], v[76:79], v[16:19], 0
v_dot2_f32_bf16 v20, v16, v80, 0
v_dot2_f32_bf16 v21, v16, v16, 0
v_dot2_f32_bf16 v20, v17, v80, v20
v_dot2_f32_bf16 v21, v17, v17, v21
v_dot2_f32_bf16 v20, v18, v80, v20
v_dot2_f32_bf16 v21, v18, v18, v21
v_dot2_f32_bf16 v20, v19, v80, v20
v_dot2_f32_bf16 v21, v19, v19, v21
s_nop 2
v_permlane32_swap_b32 v20, v21
v_add_f32 v20, v20, v21
v_mov_b32 v21, v20
s_nop 1
v_permlane16_swap_b32 v20, v21
v_add_f32 v20, v20, v21
s_nop 1
v_add_f32_dpp v20, v20, v20 row_ror:4 row_mask:0xf bank_mask:0xf
s_nop 1
v_add_f32_dpp v20, v20, v20 row_ror:8 row_mask:0xf bank_mask:0xf
ds_write_b32 v6, v20 offset:8704
v_cndmask_b32 v88, v88, v92, s[90:91]
v_cndmask_b32 v89, v89, v93, s[90:91]
v_cndmask_b32 v90, v90, v94, s[90:91]
v_cndmask_b32 v91, v91, v95, s[90:91]
v_cndmask_b32 v96, v96, v100, s[94:95]
v_cndmask_b32 v97, v97, v101, s[94:95]
v_cndmask_b32 v98, v98, v102, s[94:95]
v_cndmask_b32 v99, v99, v103, s[94:95]
s_or_b64 s[92:93], s[92:93], s[94:95]
v_cndmask_b32 v88, v88, v96, s[92:93]
v_cndmask_b32 v89, v89, v97, s[92:93]
v_cndmask_b32 v90, v90, v98, s[92:93]
v_cndmask_b32 v91, v91, v99, s[92:93]
v_add_f32_dpp v88, v88, v88 row_ror:4 row_mask:0xf bank_mask:0xf
v_add_f32_dpp v89, v89, v89 row_ror:4 row_mask:0xf bank_mask:0xf
v_add_f32_dpp v90, v90, v90 row_ror:4 row_mask:0xf bank_mask:0xf
v_add_f32_dpp v91, v91, v91 row_ror:4 row_mask:0xf bank_mask:0xf
v_add_f32_dpp v88, v88, v88 row_ror:8 row_mask:0xf bank_mask:0xf
v_add_f32_dpp v89, v89, v89 row_ror:8 row_mask:0xf bank_mask:0xf
v_add_f32_dpp v90, v90, v90 row_ror:8 row_mask:0xf bank_mask:0xf
v_add_f32_dpp v91, v91, v91 row_ror:8 row_mask:0xf bank_mask:0xf
ds_write_b128 v5, v[88:91] offset:4608
s_waitcnt lgkmcnt(0)
s_barrier
s_cmp_lg_u32 s3, 0
s_cbranch_scc1 L_sdone
v_add_u32 v13, 8704, v13
ds_read2_b32 v[32:33], v13 offset0:0 offset1:32
ds_read2_b32 v[34:35], v13 offset0:64 offset1:96
ds_read2_b32 v[36:37], v13 offset0:128 offset1:160
ds_read2_b32 v[38:39], v13 offset0:192 offset1:224
ds_read_b128 v[16:19], v7 offset:4608
ds_read_b128 v[20:23], v7 offset:5632
ds_read_b128 v[24:27], v7 offset:6656
ds_read_b128 v[28:31], v7 offset:7680
s_waitcnt lgkmcnt(4)
v_add_f32 v32, v32, v34
v_add_f32 v33, v33, v35
v_add_f32 v36, v36, v38
v_add_f32 v37, v37, v39
v_add_f32 v32, v32, v36
v_add_f32 v33, v33, v37
v_mul_f32 v32, 0x3b000000, v32
v_mul_f32 v33, 0x3b000000, v33
v_fma_f32 v33, -v32, v32, v33
v_max_f32 v33, 0, v33
v_cvt_pk_bf16_f32 v32, v32, v33
v_and_b32 v33, 0xffff0000, v32
v_lshlrev_b32 v32, 16, v32
v_add_f32 v33, 0x3727c5ac, v33
v_cvt_pk_bf16_f32 v33, v33, v33
v_and_b32 v33, 0xffff0000, v33
v_sqrt_f32 v33, v33
s_nop 0
v_cvt_pk_bf16_f32 v33, v33, v33
v_and_b32 v33, 0xffff0000, v33
v_rcp_f32 v33, v33
s_waitcnt lgkmcnt(0)
v_add_f32 v16, v16, v20
v_add_f32 v24, v24, v28
v_add_f32 v17, v17, v21
v_add_f32 v25, v25, v29
v_add_f32 v18, v18, v22
v_add_f32 v26, v26, v30
v_add_f32 v19, v19, v23
v_add_f32 v27, v27, v31
v_add_f32 v16, v16, v24
v_add_f32 v17, v17, v25
v_add_f32 v18, v18, v26
v_add_f32 v19, v19, v27
v_fma_f32 v16, -v32, v84, v16
v_fma_f32 v17, -v32, v85, v17
v_fma_f32 v18, -v32, v86, v18
v_fma_f32 v19, -v32, v87, v19
v_mul_f32 v16, v16, v33
v_mul_f32 v17, v17, v33
v_mul_f32 v18, v18, v33
v_mul_f32 v19, v19, v33
v_maximum3_f32 v16, v16, 0, 0
v_maximum3_f32 v17, v17, 0, 0
v_maximum3_f32 v18, v18, 0, 0
v_maximum3_f32 v19, v19, 0, 0
v_cvt_pk_bf16_f32 v16, v16, v17
v_cvt_pk_bf16_f32 v17, v18, v19
v_and_b32 v16, 0x7fff7fff, v16
v_and_b32 v17, 0x7fff7fff, v17
buffer_store_dwordx2 v[16:17], v12, s[16:19], s59 offen sc1
s_branch L_sdone
L_ffn2:
s_sub_u32 s58, s88, 152
s_and_b32 s59, s58, 7
s_lshr_b32 s58, s58, 3
s_lshl_b32 s59, s59, 2
s_add_u32 s35, s59, s58
v_and_b32 v128, 1, v2
v_mul_u32_u24 v128, 6721536, v128
s_mov_b32 s58, 618496
buffer_load_dword v130, v128, s[16:19], s58 offen sc1
v_lshrrev_b32 v4, 4, v2
v_lshlrev_b32 v4, 8, v4
v_bfe_u32 v40, v2, 2, 2
v_lshlrev_b32 v40, 5, v40
v_add_u32 v4, v4, v40
v_and_b32 v40, 3, v2
v_lshlrev_b32 v40, 3, v40
v_add_u32 v4, v4, v40
s_mul_i32 s58, s3, 12288
s_add_u32 s58, s58, 32768
v_add_u32 v4, s58, v4
v_lshrrev_b32 v14, 1, v2
v_lshlrev_b32 v14, 10, v14
v_and_b32 v6, 1, v2
v_lshlrev_b32 v6, 4, v6
v_add_u32 v14, v14, v6
s_mul_i32 s58, s3, 393216
v_add_u32 v14, s58, v14
s_lshl_b32 s59, s35, 5
s_add_u32 s20, s50, s59
s_addc_u32 s21, s51, 0
s_sub_u32 s22, 1409024, s59
s_mov_b32 s23, 0x20000
s_mov_b32 s32, 0
buffer_load_dwordx4 v[16:19], v14, s[20:23], s32 offen nt
s_add_u32 s32, s32, 32768
buffer_load_dwordx4 v[20:23], v14, s[20:23], s32 offen nt
s_add_u32 s32, s32, 32768
buffer_load_dwordx4 v[24:27], v14, s[20:23], s32 offen nt
s_add_u32 s32, s32, 32768
buffer_load_dwordx4 v[28:31], v14, s[20:23], s32 offen nt
s_add_u32 s32, s32, 32768
buffer_load_dwordx4 v[32:35], v14, s[20:23], s32 offen nt
s_add_u32 s32, s32, 32768
buffer_load_dwordx4 v[36:39], v14, s[20:23], s32 offen nt
s_add_u32 s32, s32, 32768
buffer_load_dwordx4 v[40:43], v14, s[20:23], s32 offen nt
s_add_u32 s32, s32, 32768
buffer_load_dwordx4 v[44:47], v14, s[20:23], s32 offen nt
s_add_u32 s32, s32, 32768
buffer_load_dwordx4 v[48:51], v14, s[20:23], s32 offen nt
s_add_u32 s32, s32, 32768
buffer_load_dwordx4 v[52:55], v14, s[20:23], s32 offen nt
s_add_u32 s32, s32, 32768
buffer_load_dwordx4 v[56:59], v14, s[20:23], s32 offen nt
s_add_u32 s32, s32, 32768
buffer_load_dwordx4 v[60:63], v14, s[20:23], s32 offen nt
s_add_u32 s32, s32, 32768
v_lshlrev_b32 v15, 4, v2
s_mul_i32 s58, s3, 12288
s_add_u32 s58, s58, 32768
v_add_u32 v15, s58, v15
s_waitcnt vmcnt(11)
ds_write_b128 v15, v[16:19] offset:0
s_waitcnt vmcnt(10)
ds_write_b128 v15, v[20:23] offset:1024
s_waitcnt vmcnt(9)
ds_write_b128 v15, v[24:27] offset:2048
s_waitcnt vmcnt(8)
ds_write_b128 v15, v[28:31] offset:3072
s_waitcnt vmcnt(7)
ds_write_b128 v15, v[32:35] offset:4096
s_waitcnt vmcnt(6)
ds_write_b128 v15, v[36:39] offset:5120
s_waitcnt vmcnt(5)
ds_write_b128 v15, v[40:43] offset:6144
s_waitcnt vmcnt(4)
ds_write_b128 v15, v[44:47] offset:7168
s_waitcnt vmcnt(3)
ds_write_b128 v15, v[48:51] offset:8192
s_waitcnt vmcnt(2)
ds_write_b128 v15, v[52:55] offset:9216
s_waitcnt vmcnt(1)
ds_write_b128 v15, v[56:59] offset:10240
s_waitcnt vmcnt(0)
ds_write_b128 v15, v[60:63] offset:11264
s_waitcnt lgkmcnt(0)
ds_read_b64_tr_b16 v[64:65], v4 offset:0
ds_read_b64_tr_b16 v[66:67], v4 offset:128
ds_read_b64_tr_b16 v[68:69], v4 offset:1024
ds_read_b64_tr_b16 v[70:71], v4 offset:1152
ds_read_b64_tr_b16 v[72:73], v4 offset:2048
ds_read_b64_tr_b16 v[74:75], v4 offset:2176
ds_read_b64_tr_b16 v[76:77], v4 offset:3072
ds_read_b64_tr_b16 v[78:79], v4 offset:3200
s_waitcnt lgkmcnt(0)
ds_read_b64_tr_b16 v[80:81], v4 offset:4096
ds_read_b64_tr_b16 v[82:83], v4 offset:4224
ds_read_b64_tr_b16 v[84:85], v4 offset:5120
ds_read_b64_tr_b16 v[86:87], v4 offset:5248
ds_read_b64_tr_b16 v[88:89], v4 offset:6144
ds_read_b64_tr_b16 v[90:91], v4 offset:6272
ds_read_b64_tr_b16 v[92:93], v4 offset:7168
ds_read_b64_tr_b16 v[94:95], v4 offset:7296
s_waitcnt lgkmcnt(0)
ds_read_b64_tr_b16 v[96:97], v4 offset:8192
ds_read_b64_tr_b16 v[98:99], v4 offset:8320
ds_read_b64_tr_b16 v[100:101], v4 offset:9216
ds_read_b64_tr_b16 v[102:103], v4 offset:9344
ds_read_b64_tr_b16 v[104:105], v4 offset:10240
ds_read_b64_tr_b16 v[106:107], v4 offset:10368
ds_read_b64_tr_b16 v[108:109], v4 offset:11264
ds_read_b64_tr_b16 v[110:111], v4 offset:11392
s_waitcnt lgkmcnt(0)
s_and_b32 s58, s88, 3
s_mul_i32 s58, s58, 11264
s_add_u32 s58, s58, 565248
s_add_u32 s20, s56, s58
s_addc_u32 s21, s57, 0
s_mov_b32 s22, 11008
s_mov_b32 s23, 0x20000
v_bfe_u32 v8, v2, 2, 2
v_lshlrev_b32 v8, 8, v8
v_lshrrev_b32 v9, 5, v2
v_lshlrev_b32 v9, 7, v9
v_add_u32 v8, v8, v9
v_and_b32 v9, 3, v2
v_lshlrev_b32 v9, 5, v9
v_add_u32 v8, v8, v9
v_bfe_u32 v9, v2, 4, 1
v_lshlrev_b32 v9, 4, v9
v_add_u32 v8, v8, v9
s_mul_i32 s58, s3, 3072
v_add_u32 v8, s58, v8
v_lshrrev_b32 v10, 4, v2
v_and_b32 v11, 15, v2
s_lshl_b32 s59, s35, 4
v_add_u32 v11, s59, v11
v_lshlrev_b32 v12, 1, v11
v_lshlrev_b32 v13, 10, v10
v_add_u32 v12, v12, v13
v_lshrrev_b32 v13, 5, v11
v_lshlrev_b32 v13, 8, v13
v_lshlrev_b32 v10, 6, v10
v_add_u32 v13, v13, v10
v_and_b32 v10, 30, v11
v_lshlrev_b32 v10, 1, v10
v_add_u32 v13, v13, v10
v_lshlrev_b32 v6, 2, v2
s_lshl_b32 s58, s3, 8
v_add_u32 v5, s58, v6
v_mov_b32 v112, 0
v_mov_b32 v113, 0
v_mov_b32 v114, 0
v_mov_b32 v115, 0
v_mov_b32 v116, 0
v_mov_b32 v117, 0
v_mov_b32 v118, 0
v_mov_b32 v119, 0
v_mov_b32 v120, 0
v_mov_b32 v121, 0
v_mov_b32 v122, 0
v_mov_b32 v123, 0
v_mov_b32 v124, 0
v_mov_b32 v125, 0
v_mov_b32 v126, 0
v_mov_b32 v127, 0
s_mov_b32 s90, 0xffff0000
s_mov_b32 s91, 0
s_mov_b32 s92, 0
s_mov_b32 s93, 0xffff0000
s_mov_b32 s94, 0
s_mov_b32 s95, -1
s_waitcnt lgkmcnt(0)
s_mov_b32 s58, 557056
s_mov_b32 s12, s52
s_mov_b32 s13, s53
s_mov_b32 s14, 4096
s_mov_b32 s15, 0x20000
s_mov_b32 s63, 262144
L_f2hspin:
s_sleep 2
buffer_load_dword v14, v13, s[16:19], s58 offen sc1
s_waitcnt vmcnt(0)
v_cmp_eq_u32 vcc, -1, v14
s_cbranch_vccz L_f2hok
s_sub_u32 s63, s63, 1
s_cbranch_scc0 L_f2hspin
L_f2hok:
v_and_b32 v11, 1, v11
v_lshlrev_b32 v60, 16, v14
v_and_b32 v61, 0xffff0000, v14
v_cmp_eq_u32 vcc, 1, v11
s_nop 1
v_cndmask_b32 v60, v60, v61, vcc
s_mov_b32 s63, 262144
L_f2spin:
buffer_load_dwordx4 v[16:19], v8, s[20:23], 0 offen offset:0 sc1
buffer_load_dwordx4 v[20:23], v8, s[20:23], 0 offen offset:1024 sc1
buffer_load_dwordx4 v[24:27], v8, s[20:23], 0 offen offset:2048 sc1
s_waitcnt vmcnt(0)
v_max_u32 v15, v16, v17
v_max3_u32 v15, v15, v18, v19
v_max3_u32 v15, v15, v20, v21
v_max3_u32 v15, v15, v22, v23
v_max3_u32 v15, v15, v24, v25
v_max3_u32 v15, v15, v26, v27
v_cmp_eq_u32 vcc, -1, v15
s_cbranch_vccz L_f2ok
s_sub_u32 s63, s63, 1
s_cbranch_scc0 L_f2spin
L_f2ok:
v_mfma_f32_16x16x32_bf16 v[112:115], v[16:19], v[64:67], v[112:115]
v_mfma_f32_16x16x32_bf16 v[116:119], v[16:19], v[68:71], v[116:119]
v_mfma_f32_16x16x32_bf16 v[120:123], v[16:19], v[72:75], v[120:123]
v_mfma_f32_16x16x32_bf16 v[124:127], v[16:19], v[76:79], v[124:127]
v_mfma_f32_16x16x32_bf16 v[112:115], v[20:23], v[80:83], v[112:115]
v_mfma_f32_16x16x32_bf16 v[116:119], v[20:23], v[84:87], v[116:119]
v_mfma_f32_16x16x32_bf16 v[120:123], v[20:23], v[88:91], v[120:123]
v_mfma_f32_16x16x32_bf16 v[124:127], v[20:23], v[92:95], v[124:127]
v_mfma_f32_16x16x32_bf16 v[112:115], v[24:27], v[96:99], v[112:115]
v_mfma_f32_16x16x32_bf16 v[116:119], v[24:27], v[100:103], v[116:119]
v_mfma_f32_16x16x32_bf16 v[120:123], v[24:27], v[104:107], v[120:123]
v_mfma_f32_16x16x32_bf16 v[124:127], v[24:27], v[108:111], v[124:127]
s_nop 5
v_cndmask_b32 v112, v112, v116, s[90:91]
v_cndmask_b32 v113, v113, v117, s[90:91]
v_cndmask_b32 v114, v114, v118, s[90:91]
v_cndmask_b32 v115, v115, v119, s[90:91]
v_cndmask_b32 v120, v120, v124, s[92:93]
v_cndmask_b32 v121, v121, v125, s[92:93]
v_cndmask_b32 v122, v122, v126, s[92:93]
v_cndmask_b32 v123, v123, v127, s[92:93]
v_cndmask_b32 v112, v112, v120, s[94:95]
v_cndmask_b32 v113, v113, v121, s[94:95]
v_cndmask_b32 v114, v114, v122, s[94:95]
v_cndmask_b32 v115, v115, v123, s[94:95]
s_nop 0
v_permlane32_swap_b32 v112, v114
v_permlane32_swap_b32 v113, v115
v_add_f32 v112, v112, v114
v_add_f32 v113, v113, v115
s_nop 1
v_permlane16_swap_b32 v112, v113
v_add_f32 v112, v112, v113
ds_write_b32 v5, v112 offset:4608
s_waitcnt lgkmcnt(0)
s_barrier
s_cmp_lg_u32 s3, 0
s_cbranch_scc1 L_sdone
ds_read_b32 v120, v6 offset:4608
ds_read_b32 v121, v6 offset:4864
ds_read_b32 v122, v6 offset:5120
ds_read_b32 v123, v6 offset:5376
s_waitcnt lgkmcnt(0)
v_add_f32 v120, v120, v121
v_add_f32 v122, v122, v123
v_add_f32 v120, v120, v122
v_cvt_pk_bf16_f32 v120, v120, v120
v_and_b32 v120, 0xffff0000, v120
v_add_f32 v120, v120, v60
v_cvt_pk_bf16_f32 v120, v120, v120
buffer_store_short v120, v12, s[12:15], 0 offen
s_cmp_lg_u32 s88, 152
s_cbranch_scc1 L_noep
v_add_u32 v130, 1, v130
s_mov_b32 s58, 618496
s_mov_b64 exec, 3
buffer_store_dword v130, v128, s[16:19], s58 offen sc1
s_mov_b64 exec, -1
L_noep:
s_branch L_sdone
L_helper:
s_sub_u32 s34, s3, 4
v_lshrrev_b32 v4, 4, v2
v_and_b32 v5, 15, v2
s_lshr_b32 s35, s2, 3
s_and_b32 s35, s35, 7
s_lshl_b32 s58, s34, 10
v_lshlrev_b32 v6, 2, v5
v_add_u32 v6, v6, v4
s_lshl_b32 s59, s35, 6
v_add_u32 v6, s59, v6
v_lshlrev_b32 v6, 1, v6
v_lshlrev_b32 v7, 4, v2
v_lshlrev_b32 v3, 13, v4
v_lshlrev_b32 v14, 4, v5
v_add_u32 v3, v3, v14
s_lshl_b32 s59, s34, 17
v_add_u32 v3, s59, v3
s_lshl_b32 s32, s35, 19
s_lshl_b32 s59, s28, 8
s_sub_u32 s60, 4194304, s59
s_waitcnt lgkmcnt(0)
s_mov_b32 s16, s56
s_mov_b32 s17, s57
s_mov_b32 s18, 7344128
s_mov_b32 s19, 0x20000
v_and_b32 v46, 1, v2
v_mul_u32_u24 v46, 6721536, v46
s_mov_b32 s61, 618496
buffer_load_dword v44, v46, s[16:19], s61 offen sc1
s_add_u32 s20, s36, s58
s_addc_u32 s21, s37, 0
s_mov_b32 s22, 1024
s_mov_b32 s23, 0x20000
buffer_load_dwordx4 v[8:11], v7, s[20:23], 0 offen
buffer_load_ushort v12, v6, s[20:23], 0 offen
s_add_u32 s12, s42, s59
s_addc_u32 s13, s43, 0
s_mov_b32 s14, s60
s_mov_b32 s15, 0x20000
buffer_load_dwordx4 v[128:131], v3, s[12:15], s32 offen nt
s_add_u32 s32, s32, 32768
buffer_load_dwordx4 v[132:135], v3, s[12:15], s32 offen nt
s_add_u32 s32, s32, 32768
buffer_load_dwordx4 v[136:139], v3, s[12:15], s32 offen nt
s_add_u32 s32, s32, 32768
buffer_load_dwordx4 v[140:143], v3, s[12:15], s32 offen nt
v_lshlrev_b32 v14, 2, v2
v_mov_b32 v15, -1
s_mov_b64 exec, 0xfff
ds_write_b32 v14, v15 offset:4096
s_mov_b64 exec, 1
ds_write_b32 v14, v15 offset:4172
s_mov_b64 exec, 3
v_mov_b32 v15, 0
ds_write_b32 v14, v15 offset:4160
ds_write_b32 v14, v15 offset:4176
ds_write_b32 v14, v15 offset:4184
s_mov_b64 exec, -1
s_waitcnt lgkmcnt(0)
s_barrier
v_add_u32 v13, 32768, v7
s_lshl_b32 s58, s34, 12
v_add_u32 v14, s58, v13
s_lshl_b32 s59, s28, 2
s_add_u32 s60, s59, s34
s_lshl_b32 s60, s60, 3
s_add_u32 s60, s60, s35
s_lshl_b32 s60, s60, 10
s_add_u32 s60, s60, 6291456
s_add_u32 s59, s59, s29
s_lshl_b32 s59, s59, 3
s_lshl_b32 s61, s34, 1
s_add_u32 s59, s59, s61
s_lshl_b32 s59, s59, 10
s_add_u32 s59, s59, 6291456
s_waitcnt vmcnt(4)
v_readlane_b32 s86, v44, 0
v_readlane_b32 s87, v44, 1
s_add_u32 s86, s86, 1
s_add_u32 s87, s87, 1
v_lshlrev_b32 v32, 16, v8
v_and_b32 v33, 0xffff0000, v8
v_lshlrev_b32 v34, 16, v9
v_and_b32 v35, 0xffff0000, v9
v_lshlrev_b32 v36, 16, v10
v_and_b32 v37, 0xffff0000, v10
v_lshlrev_b32 v38, 16, v11
v_and_b32 v39, 0xffff0000, v11
v_add_f32 v40, v32, v33
v_add_f32 v41, v34, v35
v_add_f32 v42, v36, v37
v_add_f32 v43, v38, v39
v_add_f32 v40, v40, v41
v_add_f32 v42, v42, v43
v_add_f32 v40, v40, v42
s_nop 1
v_add_f32_dpp v40, v40, v40 row_ror:8 row_mask:0xf bank_mask:0xf
s_nop 1
v_add_f32_dpp v40, v40, v40 row_ror:4 row_mask:0xf bank_mask:0xf
s_nop 1
v_add_f32_dpp v40, v40, v40 row_ror:2 row_mask:0xf bank_mask:0xf
s_nop 1
v_add_f32_dpp v40, v40, v40 row_ror:1 row_mask:0xf bank_mask:0xf
v_mov_b32 v41, v40
s_nop 1
v_permlane16_swap_b32 v40, v41
v_add_f32 v40, v40, v41
v_mov_b32 v41, v40
s_nop 1
v_permlane32_swap_b32 v40, v41
v_add_f32 v40, v40, v41
v_mul_f32 v40, 0x3b000000, v40
v_sub_f32 v32, v32, v40
v_sub_f32 v33, v33, v40
v_sub_f32 v34, v34, v40
v_sub_f32 v35, v35, v40
v_sub_f32 v36, v36, v40
v_sub_f32 v37, v37, v40
v_sub_f32 v38, v38, v40
v_sub_f32 v39, v39, v40
v_mul_f32 v42, v32, v32
v_fmac_f32 v42, v33, v33
v_fmac_f32 v42, v34, v34
v_fmac_f32 v42, v35, v35
v_fmac_f32 v42, v36, v36
v_fmac_f32 v42, v37, v37
v_fmac_f32 v42, v38, v38
v_fmac_f32 v42, v39, v39
s_nop 1
v_add_f32_dpp v42, v42, v42 row_ror:8 row_mask:0xf bank_mask:0xf
s_nop 1
v_add_f32_dpp v42, v42, v42 row_ror:4 row_mask:0xf bank_mask:0xf
s_nop 1
v_add_f32_dpp v42, v42, v42 row_ror:2 row_mask:0xf bank_mask:0xf
s_nop 1
v_add_f32_dpp v42, v42, v42 row_ror:1 row_mask:0xf bank_mask:0xf
v_mov_b32 v41, v42
s_nop 1
v_permlane16_swap_b32 v42, v41
v_add_f32 v42, v42, v41
v_mov_b32 v41, v42
s_nop 1
v_permlane32_swap_b32 v42, v41
v_add_f32 v42, v42, v41
v_mul_f32 v42, 0x3b000000, v42
v_cvt_pk_bf16_f32 v40, v40, v40
v_and_b32 v40, 0xffff0000, v40
v_cvt_pk_bf16_f32 v42, v42, v42
v_and_b32 v42, 0xffff0000, v42
v_add_f32 v42, 0x3727c5ac, v42
v_cvt_pk_bf16_f32 v42, v42, v42
v_and_b32 v42, 0xffff0000, v42
v_sqrt_f32 v42, v42
s_nop 0
v_cvt_pk_bf16_f32 v42, v42, v42
v_and_b32 v42, 0xffff0000, v42
v_rcp_f32 v42, v42
v_lshlrev_b32 v12, 16, v12
v_sub_f32 v12, v12, v40
v_cvt_pk_bf16_f32 v12, v12, v12
v_and_b32 v12, 0xffff0000, v12
v_mul_f32 v12, v12, v42
v_mov_b32 v15, 0
v_cvt_pk_bf16_f32 v24, v12, v15
v_cvt_pk_bf16_f32 v25, v15, v12
s_waitcnt vmcnt(0)
ds_write_b128 v14, v[128:131] offset:0
ds_write_b128 v14, v[132:135] offset:1024
ds_write_b128 v14, v[136:139] offset:2048
ds_write_b128 v14, v[140:143] offset:3072
v_mov_b32 v14, 4164
v_mov_b32 v15, 1
s_waitcnt lgkmcnt(0)
s_mov_b64 exec, 1
ds_add_u32 v14, v15
s_mov_b64 exec, -1
s_mov_b32 s63, 262144
L_wspin:
ds_read_b32 v15, v14
s_waitcnt lgkmcnt(0)
v_cmp_gt_u32 vcc, 4, v15
s_cbranch_vccz L_wok
s_sub_u32 s63, s63, 1
s_cbranch_scc0 L_wspin
L_wok:
ds_read_b128 v[128:131], v13 offset:0
ds_read_b128 v[132:135], v13 offset:1024
ds_read_b128 v[136:139], v13 offset:2048
ds_read_b128 v[140:143], v13 offset:3072
ds_read_b128 v[144:147], v13 offset:4096
ds_read_b128 v[148:151], v13 offset:5120
ds_read_b128 v[152:155], v13 offset:6144
ds_read_b128 v[156:159], v13 offset:7168
v_mov_b32 v16, 0
v_mov_b32 v17, 0
v_mov_b32 v18, 0
v_mov_b32 v19, 0
v_mov_b32 v20, 0
v_mov_b32 v21, 0
v_mov_b32 v22, 0
v_mov_b32 v23, 0
s_waitcnt lgkmcnt(4)
v_dot2c_f32_bf16_dpp v16, v24, v128 row_newbcast:0 row_mask:0xf bank_mask:0xf
v_dot2c_f32_bf16_dpp v17, v25, v128 row_newbcast:0 row_mask:0xf bank_mask:0xf
v_dot2c_f32_bf16_dpp v18, v24, v129 row_newbcast:0 row_mask:0xf bank_mask:0xf
v_dot2c_f32_bf16_dpp v19, v25, v129 row_newbcast:0 row_mask:0xf bank_mask:0xf
v_dot2c_f32_bf16_dpp v20, v24, v130 row_newbcast:0 row_mask:0xf bank_mask:0xf
v_dot2c_f32_bf16_dpp v21, v25, v130 row_newbcast:0 row_mask:0xf bank_mask:0xf
v_dot2c_f32_bf16_dpp v22, v24, v131 row_newbcast:0 row_mask:0xf bank_mask:0xf
v_dot2c_f32_bf16_dpp v23, v25, v131 row_newbcast:0 row_mask:0xf bank_mask:0xf
v_dot2c_f32_bf16_dpp v16, v24, v132 row_newbcast:1 row_mask:0xf bank_mask:0xf
v_dot2c_f32_bf16_dpp v17, v25, v132 row_newbcast:1 row_mask:0xf bank_mask:0xf
v_dot2c_f32_bf16_dpp v18, v24, v133 row_newbcast:1 row_mask:0xf bank_mask:0xf
v_dot2c_f32_bf16_dpp v19, v25, v133 row_newbcast:1 row_mask:0xf bank_mask:0xf
v_dot2c_f32_bf16_dpp v20, v24, v134 row_newbcast:1 row_mask:0xf bank_mask:0xf
v_dot2c_f32_bf16_dpp v21, v25, v134 row_newbcast:1 row_mask:0xf bank_mask:0xf
v_dot2c_f32_bf16_dpp v22, v24, v135 row_newbcast:1 row_mask:0xf bank_mask:0xf
v_dot2c_f32_bf16_dpp v23, v25, v135 row_newbcast:1 row_mask:0xf bank_mask:0xf
v_dot2c_f32_bf16_dpp v16, v24, v136 row_newbcast:2 row_mask:0xf bank_mask:0xf
v_dot2c_f32_bf16_dpp v17, v25, v136 row_newbcast:2 row_mask:0xf bank_mask:0xf
v_dot2c_f32_bf16_dpp v18, v24, v137 row_newbcast:2 row_mask:0xf bank_mask:0xf
v_dot2c_f32_bf16_dpp v19, v25, v137 row_newbcast:2 row_mask:0xf bank_mask:0xf
v_dot2c_f32_bf16_dpp v20, v24, v138 row_newbcast:2 row_mask:0xf bank_mask:0xf
v_dot2c_f32_bf16_dpp v21, v25, v138 row_newbcast:2 row_mask:0xf bank_mask:0xf
v_dot2c_f32_bf16_dpp v22, v24, v139 row_newbcast:2 row_mask:0xf bank_mask:0xf
v_dot2c_f32_bf16_dpp v23, v25, v139 row_newbcast:2 row_mask:0xf bank_mask:0xf
v_dot2c_f32_bf16_dpp v16, v24, v140 row_newbcast:3 row_mask:0xf bank_mask:0xf
v_dot2c_f32_bf16_dpp v17, v25, v140 row_newbcast:3 row_mask:0xf bank_mask:0xf
v_dot2c_f32_bf16_dpp v18, v24, v141 row_newbcast:3 row_mask:0xf bank_mask:0xf
v_dot2c_f32_bf16_dpp v19, v25, v141 row_newbcast:3 row_mask:0xf bank_mask:0xf
v_dot2c_f32_bf16_dpp v20, v24, v142 row_newbcast:3 row_mask:0xf bank_mask:0xf
v_dot2c_f32_bf16_dpp v21, v25, v142 row_newbcast:3 row_mask:0xf bank_mask:0xf
v_dot2c_f32_bf16_dpp v22, v24, v143 row_newbcast:3 row_mask:0xf bank_mask:0xf
v_dot2c_f32_bf16_dpp v23, v25, v143 row_newbcast:3 row_mask:0xf bank_mask:0xf
s_waitcnt lgkmcnt(0)
ds_read_b128 v[160:163], v13 offset:8192
ds_read_b128 v[164:167], v13 offset:9216
ds_read_b128 v[168:171], v13 offset:10240
ds_read_b128 v[172:175], v13 offset:11264
ds_read_b128 v[176:179], v13 offset:12288
ds_read_b128 v[180:183], v13 offset:13312
ds_read_b128 v[184:187], v13 offset:14336
ds_read_b128 v[188:191], v13 offset:15360
v_dot2c_f32_bf16_dpp v16, v24, v144 row_newbcast:4 row_mask:0xf bank_mask:0xf
v_dot2c_f32_bf16_dpp v17, v25, v144 row_newbcast:4 row_mask:0xf bank_mask:0xf
v_dot2c_f32_bf16_dpp v18, v24, v145 row_newbcast:4 row_mask:0xf bank_mask:0xf
v_dot2c_f32_bf16_dpp v19, v25, v145 row_newbcast:4 row_mask:0xf bank_mask:0xf
v_dot2c_f32_bf16_dpp v20, v24, v146 row_newbcast:4 row_mask:0xf bank_mask:0xf
v_dot2c_f32_bf16_dpp v21, v25, v146 row_newbcast:4 row_mask:0xf bank_mask:0xf
v_dot2c_f32_bf16_dpp v22, v24, v147 row_newbcast:4 row_mask:0xf bank_mask:0xf
v_dot2c_f32_bf16_dpp v23, v25, v147 row_newbcast:4 row_mask:0xf bank_mask:0xf
v_dot2c_f32_bf16_dpp v16, v24, v148 row_newbcast:5 row_mask:0xf bank_mask:0xf
v_dot2c_f32_bf16_dpp v17, v25, v148 row_newbcast:5 row_mask:0xf bank_mask:0xf
v_dot2c_f32_bf16_dpp v18, v24, v149 row_newbcast:5 row_mask:0xf bank_mask:0xf
v_dot2c_f32_bf16_dpp v19, v25, v149 row_newbcast:5 row_mask:0xf bank_mask:0xf
v_dot2c_f32_bf16_dpp v20, v24, v150 row_newbcast:5 row_mask:0xf bank_mask:0xf
v_dot2c_f32_bf16_dpp v21, v25, v150 row_newbcast:5 row_mask:0xf bank_mask:0xf
v_dot2c_f32_bf16_dpp v22, v24, v151 row_newbcast:5 row_mask:0xf bank_mask:0xf
v_dot2c_f32_bf16_dpp v23, v25, v151 row_newbcast:5 row_mask:0xf bank_mask:0xf
v_dot2c_f32_bf16_dpp v16, v24, v152 row_newbcast:6 row_mask:0xf bank_mask:0xf
v_dot2c_f32_bf16_dpp v17, v25, v152 row_newbcast:6 row_mask:0xf bank_mask:0xf
v_dot2c_f32_bf16_dpp v18, v24, v153 row_newbcast:6 row_mask:0xf bank_mask:0xf
v_dot2c_f32_bf16_dpp v19, v25, v153 row_newbcast:6 row_mask:0xf bank_mask:0xf
v_dot2c_f32_bf16_dpp v20, v24, v154 row_newbcast:6 row_mask:0xf bank_mask:0xf
v_dot2c_f32_bf16_dpp v21, v25, v154 row_newbcast:6 row_mask:0xf bank_mask:0xf
v_dot2c_f32_bf16_dpp v22, v24, v155 row_newbcast:6 row_mask:0xf bank_mask:0xf
v_dot2c_f32_bf16_dpp v23, v25, v155 row_newbcast:6 row_mask:0xf bank_mask:0xf
v_dot2c_f32_bf16_dpp v16, v24, v156 row_newbcast:7 row_mask:0xf bank_mask:0xf
v_dot2c_f32_bf16_dpp v17, v25, v156 row_newbcast:7 row_mask:0xf bank_mask:0xf
v_dot2c_f32_bf16_dpp v18, v24, v157 row_newbcast:7 row_mask:0xf bank_mask:0xf
v_dot2c_f32_bf16_dpp v19, v25, v157 row_newbcast:7 row_mask:0xf bank_mask:0xf
v_dot2c_f32_bf16_dpp v20, v24, v158 row_newbcast:7 row_mask:0xf bank_mask:0xf
v_dot2c_f32_bf16_dpp v21, v25, v158 row_newbcast:7 row_mask:0xf bank_mask:0xf
v_dot2c_f32_bf16_dpp v22, v24, v159 row_newbcast:7 row_mask:0xf bank_mask:0xf
v_dot2c_f32_bf16_dpp v23, v25, v159 row_newbcast:7 row_mask:0xf bank_mask:0xf
s_waitcnt lgkmcnt(4)
v_dot2c_f32_bf16_dpp v16, v24, v160 row_newbcast:8 row_mask:0xf bank_mask:0xf
v_dot2c_f32_bf16_dpp v17, v25, v160 row_newbcast:8 row_mask:0xf bank_mask:0xf
v_dot2c_f32_bf16_dpp v18, v24, v161 row_newbcast:8 row_mask:0xf bank_mask:0xf
v_dot2c_f32_bf16_dpp v19, v25, v161 row_newbcast:8 row_mask:0xf bank_mask:0xf
v_dot2c_f32_bf16_dpp v20, v24, v162 row_newbcast:8 row_mask:0xf bank_mask:0xf
v_dot2c_f32_bf16_dpp v21, v25, v162 row_newbcast:8 row_mask:0xf bank_mask:0xf
v_dot2c_f32_bf16_dpp v22, v24, v163 row_newbcast:8 row_mask:0xf bank_mask:0xf
v_dot2c_f32_bf16_dpp v23, v25, v163 row_newbcast:8 row_mask:0xf bank_mask:0xf
v_dot2c_f32_bf16_dpp v16, v24, v164 row_newbcast:9 row_mask:0xf bank_mask:0xf
v_dot2c_f32_bf16_dpp v17, v25, v164 row_newbcast:9 row_mask:0xf bank_mask:0xf
v_dot2c_f32_bf16_dpp v18, v24, v165 row_newbcast:9 row_mask:0xf bank_mask:0xf
v_dot2c_f32_bf16_dpp v19, v25, v165 row_newbcast:9 row_mask:0xf bank_mask:0xf
v_dot2c_f32_bf16_dpp v20, v24, v166 row_newbcast:9 row_mask:0xf bank_mask:0xf
v_dot2c_f32_bf16_dpp v21, v25, v166 row_newbcast:9 row_mask:0xf bank_mask:0xf
v_dot2c_f32_bf16_dpp v22, v24, v167 row_newbcast:9 row_mask:0xf bank_mask:0xf
v_dot2c_f32_bf16_dpp v23, v25, v167 row_newbcast:9 row_mask:0xf bank_mask:0xf
v_dot2c_f32_bf16_dpp v16, v24, v168 row_newbcast:10 row_mask:0xf bank_mask:0xf
v_dot2c_f32_bf16_dpp v17, v25, v168 row_newbcast:10 row_mask:0xf bank_mask:0xf
v_dot2c_f32_bf16_dpp v18, v24, v169 row_newbcast:10 row_mask:0xf bank_mask:0xf
v_dot2c_f32_bf16_dpp v19, v25, v169 row_newbcast:10 row_mask:0xf bank_mask:0xf
v_dot2c_f32_bf16_dpp v20, v24, v170 row_newbcast:10 row_mask:0xf bank_mask:0xf
v_dot2c_f32_bf16_dpp v21, v25, v170 row_newbcast:10 row_mask:0xf bank_mask:0xf
v_dot2c_f32_bf16_dpp v22, v24, v171 row_newbcast:10 row_mask:0xf bank_mask:0xf
v_dot2c_f32_bf16_dpp v23, v25, v171 row_newbcast:10 row_mask:0xf bank_mask:0xf
v_dot2c_f32_bf16_dpp v16, v24, v172 row_newbcast:11 row_mask:0xf bank_mask:0xf
v_dot2c_f32_bf16_dpp v17, v25, v172 row_newbcast:11 row_mask:0xf bank_mask:0xf
v_dot2c_f32_bf16_dpp v18, v24, v173 row_newbcast:11 row_mask:0xf bank_mask:0xf
v_dot2c_f32_bf16_dpp v19, v25, v173 row_newbcast:11 row_mask:0xf bank_mask:0xf
v_dot2c_f32_bf16_dpp v20, v24, v174 row_newbcast:11 row_mask:0xf bank_mask:0xf
v_dot2c_f32_bf16_dpp v21, v25, v174 row_newbcast:11 row_mask:0xf bank_mask:0xf
v_dot2c_f32_bf16_dpp v22, v24, v175 row_newbcast:11 row_mask:0xf bank_mask:0xf
v_dot2c_f32_bf16_dpp v23, v25, v175 row_newbcast:11 row_mask:0xf bank_mask:0xf
s_waitcnt lgkmcnt(0)
v_dot2c_f32_bf16_dpp v16, v24, v176 row_newbcast:12 row_mask:0xf bank_mask:0xf
v_dot2c_f32_bf16_dpp v17, v25, v176 row_newbcast:12 row_mask:0xf bank_mask:0xf
v_dot2c_f32_bf16_dpp v18, v24, v177 row_newbcast:12 row_mask:0xf bank_mask:0xf
v_dot2c_f32_bf16_dpp v19, v25, v177 row_newbcast:12 row_mask:0xf bank_mask:0xf
v_dot2c_f32_bf16_dpp v20, v24, v178 row_newbcast:12 row_mask:0xf bank_mask:0xf
v_dot2c_f32_bf16_dpp v21, v25, v178 row_newbcast:12 row_mask:0xf bank_mask:0xf
v_dot2c_f32_bf16_dpp v22, v24, v179 row_newbcast:12 row_mask:0xf bank_mask:0xf
v_dot2c_f32_bf16_dpp v23, v25, v179 row_newbcast:12 row_mask:0xf bank_mask:0xf
v_dot2c_f32_bf16_dpp v16, v24, v180 row_newbcast:13 row_mask:0xf bank_mask:0xf
v_dot2c_f32_bf16_dpp v17, v25, v180 row_newbcast:13 row_mask:0xf bank_mask:0xf
v_dot2c_f32_bf16_dpp v18, v24, v181 row_newbcast:13 row_mask:0xf bank_mask:0xf
v_dot2c_f32_bf16_dpp v19, v25, v181 row_newbcast:13 row_mask:0xf bank_mask:0xf
v_dot2c_f32_bf16_dpp v20, v24, v182 row_newbcast:13 row_mask:0xf bank_mask:0xf
v_dot2c_f32_bf16_dpp v21, v25, v182 row_newbcast:13 row_mask:0xf bank_mask:0xf
v_dot2c_f32_bf16_dpp v22, v24, v183 row_newbcast:13 row_mask:0xf bank_mask:0xf
v_dot2c_f32_bf16_dpp v23, v25, v183 row_newbcast:13 row_mask:0xf bank_mask:0xf
v_dot2c_f32_bf16_dpp v16, v24, v184 row_newbcast:14 row_mask:0xf bank_mask:0xf
v_dot2c_f32_bf16_dpp v17, v25, v184 row_newbcast:14 row_mask:0xf bank_mask:0xf
v_dot2c_f32_bf16_dpp v18, v24, v185 row_newbcast:14 row_mask:0xf bank_mask:0xf
v_dot2c_f32_bf16_dpp v19, v25, v185 row_newbcast:14 row_mask:0xf bank_mask:0xf
v_dot2c_f32_bf16_dpp v20, v24, v186 row_newbcast:14 row_mask:0xf bank_mask:0xf
v_dot2c_f32_bf16_dpp v21, v25, v186 row_newbcast:14 row_mask:0xf bank_mask:0xf
v_dot2c_f32_bf16_dpp v22, v24, v187 row_newbcast:14 row_mask:0xf bank_mask:0xf
v_dot2c_f32_bf16_dpp v23, v25, v187 row_newbcast:14 row_mask:0xf bank_mask:0xf
v_dot2c_f32_bf16_dpp v16, v24, v188 row_newbcast:15 row_mask:0xf bank_mask:0xf
v_dot2c_f32_bf16_dpp v17, v25, v188 row_newbcast:15 row_mask:0xf bank_mask:0xf
v_dot2c_f32_bf16_dpp v18, v24, v189 row_newbcast:15 row_mask:0xf bank_mask:0xf
v_dot2c_f32_bf16_dpp v19, v25, v189 row_newbcast:15 row_mask:0xf bank_mask:0xf
v_dot2c_f32_bf16_dpp v20, v24, v190 row_newbcast:15 row_mask:0xf bank_mask:0xf
v_dot2c_f32_bf16_dpp v21, v25, v190 row_newbcast:15 row_mask:0xf bank_mask:0xf
v_dot2c_f32_bf16_dpp v22, v24, v191 row_newbcast:15 row_mask:0xf bank_mask:0xf
v_dot2c_f32_bf16_dpp v23, v25, v191 row_newbcast:15 row_mask:0xf bank_mask:0xf
v_permlane32_swap_b32 v16, v20
v_permlane32_swap_b32 v17, v21
v_permlane32_swap_b32 v18, v22
v_permlane32_swap_b32 v19, v23
v_add_f32 v16, v16, v20
v_add_f32 v17, v17, v21
v_add_f32 v18, v18, v22
v_add_f32 v19, v19, v23
s_nop 0
v_permlane16_swap_b32 v16, v18
v_permlane16_swap_b32 v17, v19
v_add_f32 v16, v16, v18
v_add_f32 v17, v17, v19
v_mov_b32 v18, s86
v_mov_b32 v19, s87
buffer_store_dwordx4 v[16:19], v7, s[16:19], s60 offen sc1
s_waitcnt vmcnt(0)
s_mov_b32 s63, 262144
L_qxspin:
buffer_load_dwordx4 v[32:35], v7, s[16:19], s59 offen sc1
buffer_load_dwordx4 v[36:39], v7, s[16:19], s59 offen offset:1024 sc1
s_waitcnt vmcnt(0)
v_xor_b32 v34, s86, v34
v_xor_b32 v35, s87, v35
v_xor_b32 v38, s86, v38
v_xor_b32 v39, s87, v39
v_or_b32 v34, v34, v35
v_or3_b32 v34, v34, v38, v39
v_cmp_ne_u32 vcc, 0, v34
s_cbranch_vccz L_qxok
s_sub_u32 s63, s63, 1
s_cbranch_scc0 L_qxspin
L_qxok:
v_add_f32 v16, v32, v36
v_add_f32 v17, v33, v37
v_lshlrev_b32 v14, 5, v5
v_lshlrev_b32 v15, 3, v4
v_add_u32 v14, v14, v15
s_lshl_b32 s58, s34, 9
v_add_u32 v14, s58, v14
ds_write_b64 v14, v[16:17] offset:0
s_waitcnt lgkmcnt(0)
s_barrier
s_cmp_lg_u32 s34, 0
s_cbranch_scc1 L_nopoison
v_mov_b32 v32, -1
v_mov_b32 v33, -1
v_mov_b32 v34, -1
v_mov_b32 v35, -1
v_lshrrev_b32 v14, 3, v2
v_lshlrev_b32 v14, 13, v14
v_and_b32 v15, 7, v2
v_lshlrev_b32 v15, 4, v15
v_add_u32 v14, v14, v15
s_lshl_b32 s58, s29, 17
s_lshl_b32 s59, s62, 7
s_add_u32 s58, s58, s59
buffer_store_dwordx4 v[32:35], v14, s[16:19], s58 offen sc1
s_add_u32 s58, s58, 65536
buffer_store_dwordx4 v[32:35], v14, s[16:19], s58 offen sc1
v_lshlrev_b32 v14, 2, v2
s_lshl_b32 s58, s31, 7
s_add_u32 s58, s58, 622592
s_cmp_ge_u32 s2, 64
s_cbranch_scc1 L_pnored
s_and_b32 s58, s2, 15
s_lshl_b32 s58, s58, 8
s_lshr_b32 s59, s2, 4
s_lshl_b32 s59, s59, 6
s_add_u32 s58, s58, s59
s_add_u32 s58, s58, 524288
v_lshrrev_b32 v36, 4, v2
v_lshlrev_b32 v36, 12, v36
v_and_b32 v37, 15, v2
v_lshlrev_b32 v37, 2, v37
v_add_u32 v36, v36, v37
buffer_store_dword v32, v36, s[16:19], s58 offen sc1
s_add_u32 s58, s58, 16384
buffer_store_dword v32, v36, s[16:19], s58 offen sc1
s_add_u32 s58, s58, 16384
s_mov_b64 exec, 0xffff
buffer_store_dword v32, v37, s[16:19], s58 offen sc1
s_mov_b64 exec, -1
s_branch L_pdone
L_pnored:
s_cmp_ge_u32 s2, 152
s_cbranch_scc1 L_pdone
s_sub_u32 s58, s2, 64
s_and_b32 s59, s58, 7
s_lshr_b32 s58, s58, 3
s_lshr_b32 s60, s58, 2
s_lshl_b32 s60, s60, 3
s_add_u32 s60, s60, s59
s_lshl_b32 s60, s60, 2
s_and_b32 s61, s58, 3
s_add_u32 s60, s60, s61
s_mul_i32 s59, s59, 3
s_add_u32 s59, s59, s58
s_add_u32 s59, s59, 56
s_cmp_lt_u32 s58, 8
s_cselect_b32 s35, s60, s59
s_cmp_ge_u32 s35, 86
s_cbranch_scc1 L_pdone
s_lshl_b32 s58, s35, 7
s_add_u32 s58, s58, 565248
v_lshrrev_b32 v36, 4, v2
v_mul_u32_u24 v36, 11264, v36
v_and_b32 v37, 15, v2
v_lshlrev_b32 v37, 3, v37
v_add_u32 v36, v36, v37
buffer_store_dwordx2 v[32:33], v36, s[16:19], s58 offen sc1
L_pdone:
L_nopoison:
L_rpdone:
s_waitcnt vmcnt(0)
s_cmp_lg_u32 s34, 0
s_cbranch_scc1 L_nosig
s_lshl_b32 s58, s2, 2
s_add_u32 s58, s58, 663552
s_mul_i32 s59, s87, 3
s_add_u32 s59, s59, s86
v_lshlrev_b32 v14, 10, v2
v_mov_b32 v15, s59
s_mov_b64 exec, 0xf
buffer_store_dword v15, v14, s[16:19], s58 offen sc1
s_mov_b64 exec, -1
L_nosig:
v_lshlrev_b32 v3, 10, v4
v_lshlrev_b32 v14, 4, v5
v_add_u32 v3, v3, v14
s_lshl_b32 s59, s34, 8
v_add_u32 v3, s59, v3
s_lshl_b32 s59, s28, 17
s_add_u32 s12, s44, s59
s_addc_u32 s13, s45, 0
s_mov_b32 s14, 131072
s_mov_b32 s15, 0x20000
s_mul_i32 s58, s34, 9216
s_add_u32 s58, s58, 32768
v_mul_u32_u24 v6, 288, v4
v_add_u32 v6, v6, v14
v_add_u32 v6, s58, v6
v_lshlrev_b32 v7, 3, v4
v_lshrrev_b32 v15, 2, v5
v_add_u32 v7, v7, v15
v_mul_u32_u24 v7, 288, v7
v_and_b32 v15, 3, v5
v_lshlrev_b32 v15, 3, v15
v_add_u32 v7, v7, v15
v_add_u32 v7, s58, v7
s_mov_b32 s32, 0
buffer_load_dwordx4 v[32:35], v3, s[12:15], s32 offen nt
s_add_u32 s32, s32, 4096
buffer_load_dwordx4 v[36:39], v3, s[12:15], s32 offen nt
s_add_u32 s32, s32, 4096
s_waitcnt vmcnt(0)
buffer_load_dwordx4 v[40:43], v3, s[12:15], s32 offen nt
s_add_u32 s32, s32, 4096
buffer_load_dwordx4 v[44:47], v3, s[12:15], s32 offen nt
s_add_u32 s32, s32, 4096
s_waitcnt vmcnt(0)
buffer_load_dwordx4 v[48:51], v3, s[12:15], s32 offen nt
s_add_u32 s32, s32, 4096
buffer_load_dwordx4 v[52:55], v3, s[12:15], s32 offen nt
s_add_u32 s32, s32, 4096
s_waitcnt vmcnt(0)
buffer_load_dwordx4 v[56:59], v3, s[12:15], s32 offen nt
s_add_u32 s32, s32, 4096
buffer_load_dwordx4 v[60:63], v3, s[12:15], s32 offen nt
s_add_u32 s32, s32, 4096
s_waitcnt vmcnt(0)
s_waitcnt vmcnt(0)
ds_write_b128 v6, v[32:35] offset:0
ds_write_b128 v6, v[36:39] offset:1152
ds_write_b128 v6, v[40:43] offset:2304
ds_write_b128 v6, v[44:47] offset:3456
ds_write_b128 v6, v[48:51] offset:4608
ds_write_b128 v6, v[52:55] offset:5760
ds_write_b128 v6, v[56:59] offset:6912
ds_write_b128 v6, v[60:63] offset:8064
s_waitcnt lgkmcnt(0)
ds_read_b64_tr_b16 v[128:129], v7 offset:0
ds_read_b64_tr_b16 v[130:131], v7 offset:1152
ds_read_b64_tr_b16 v[132:133], v7 offset:32
ds_read_b64_tr_b16 v[134:135], v7 offset:1184
ds_read_b64_tr_b16 v[136:137], v7 offset:64
ds_read_b64_tr_b16 v[138:139], v7 offset:1216
ds_read_b64_tr_b16 v[140:141], v7 offset:96
ds_read_b64_tr_b16 v[142:143], v7 offset:1248
ds_read_b64_tr_b16 v[144:145], v7 offset:128
ds_read_b64_tr_b16 v[146:147], v7 offset:1280
ds_read_b64_tr_b16 v[148:149], v7 offset:160
ds_read_b64_tr_b16 v[150:151], v7 offset:1312
ds_read_b64_tr_b16 v[152:153], v7 offset:192
ds_read_b64_tr_b16 v[154:155], v7 offset:1344
ds_read_b64_tr_b16 v[156:157], v7 offset:224
ds_read_b64_tr_b16 v[158:159], v7 offset:1376
s_waitcnt lgkmcnt(0)
buffer_load_dwordx4 v[32:35], v3, s[12:15], s32 offen nt
s_add_u32 s32, s32, 4096
buffer_load_dwordx4 v[36:39], v3, s[12:15], s32 offen nt
s_add_u32 s32, s32, 4096
s_waitcnt vmcnt(0)
buffer_load_dwordx4 v[40:43], v3, s[12:15], s32 offen nt
s_add_u32 s32, s32, 4096
buffer_load_dwordx4 v[44:47], v3, s[12:15], s32 offen nt
s_add_u32 s32, s32, 4096
s_waitcnt vmcnt(0)
buffer_load_dwordx4 v[48:51], v3, s[12:15], s32 offen nt
s_add_u32 s32, s32, 4096
buffer_load_dwordx4 v[52:55], v3, s[12:15], s32 offen nt
s_add_u32 s32, s32, 4096
s_waitcnt vmcnt(0)
buffer_load_dwordx4 v[56:59], v3, s[12:15], s32 offen nt
s_add_u32 s32, s32, 4096
buffer_load_dwordx4 v[60:63], v3, s[12:15], s32 offen nt
s_add_u32 s32, s32, 4096
s_waitcnt vmcnt(0)
s_waitcnt vmcnt(0)
ds_write_b128 v6, v[32:35] offset:0
ds_write_b128 v6, v[36:39] offset:1152
ds_write_b128 v6, v[40:43] offset:2304
ds_write_b128 v6, v[44:47] offset:3456
ds_write_b128 v6, v[48:51] offset:4608
ds_write_b128 v6, v[52:55] offset:5760
ds_write_b128 v6, v[56:59] offset:6912
ds_write_b128 v6, v[60:63] offset:8064
s_waitcnt lgkmcnt(0)
ds_read_b64_tr_b16 v[160:161], v7 offset:0
ds_read_b64_tr_b16 v[162:163], v7 offset:1152
ds_read_b64_tr_b16 v[164:165], v7 offset:32
ds_read_b64_tr_b16 v[166:167], v7 offset:1184
ds_read_b64_tr_b16 v[168:169], v7 offset:64
ds_read_b64_tr_b16 v[170:171], v7 offset:1216
ds_read_b64_tr_b16 v[172:173], v7 offset:96
ds_read_b64_tr_b16 v[174:175], v7 offset:1248
ds_read_b64_tr_b16 v[176:177], v7 offset:128
ds_read_b64_tr_b16 v[178:179], v7 offset:1280
ds_read_b64_tr_b16 v[180:181], v7 offset:160
ds_read_b64_tr_b16 v[182:183], v7 offset:1312
ds_read_b64_tr_b16 v[184:185], v7 offset:192
ds_read_b64_tr_b16 v[186:187], v7 offset:1344
ds_read_b64_tr_b16 v[188:189], v7 offset:224
ds_read_b64_tr_b16 v[190:191], v7 offset:1376
s_waitcnt lgkmcnt(0)
buffer_load_dwordx4 v[32:35], v3, s[12:15], s32 offen nt
s_add_u32 s32, s32, 4096
buffer_load_dwordx4 v[36:39], v3, s[12:15], s32 offen nt
s_add_u32 s32, s32, 4096
s_waitcnt vmcnt(0)
buffer_load_dwordx4 v[40:43], v3, s[12:15], s32 offen nt
s_add_u32 s32, s32, 4096
buffer_load_dwordx4 v[44:47], v3, s[12:15], s32 offen nt
s_add_u32 s32, s32, 4096
s_waitcnt vmcnt(0)
buffer_load_dwordx4 v[48:51], v3, s[12:15], s32 offen nt
s_add_u32 s32, s32, 4096
buffer_load_dwordx4 v[52:55], v3, s[12:15], s32 offen nt
s_add_u32 s32, s32, 4096
s_waitcnt vmcnt(0)
buffer_load_dwordx4 v[56:59], v3, s[12:15], s32 offen nt
s_add_u32 s32, s32, 4096
buffer_load_dwordx4 v[60:63], v3, s[12:15], s32 offen nt
s_add_u32 s32, s32, 4096
s_waitcnt vmcnt(0)
s_waitcnt vmcnt(0)
ds_write_b128 v6, v[32:35] offset:0
ds_write_b128 v6, v[36:39] offset:1152
ds_write_b128 v6, v[40:43] offset:2304
ds_write_b128 v6, v[44:47] offset:3456
ds_write_b128 v6, v[48:51] offset:4608
ds_write_b128 v6, v[52:55] offset:5760
ds_write_b128 v6, v[56:59] offset:6912
ds_write_b128 v6, v[60:63] offset:8064
s_waitcnt lgkmcnt(0)
ds_read_b64_tr_b16 v[192:193], v7 offset:0
ds_read_b64_tr_b16 v[194:195], v7 offset:1152
ds_read_b64_tr_b16 v[196:197], v7 offset:32
ds_read_b64_tr_b16 v[198:199], v7 offset:1184
ds_read_b64_tr_b16 v[200:201], v7 offset:64
ds_read_b64_tr_b16 v[202:203], v7 offset:1216
ds_read_b64_tr_b16 v[204:205], v7 offset:96
ds_read_b64_tr_b16 v[206:207], v7 offset:1248
ds_read_b64_tr_b16 v[208:209], v7 offset:128
ds_read_b64_tr_b16 v[210:211], v7 offset:1280
ds_read_b64_tr_b16 v[212:213], v7 offset:160
ds_read_b64_tr_b16 v[214:215], v7 offset:1312
ds_read_b64_tr_b16 v[216:217], v7 offset:192
ds_read_b64_tr_b16 v[218:219], v7 offset:1344
ds_read_b64_tr_b16 v[220:221], v7 offset:224
ds_read_b64_tr_b16 v[222:223], v7 offset:1376
s_waitcnt lgkmcnt(0)
buffer_load_dwordx4 v[32:35], v3, s[12:15], s32 offen nt
s_add_u32 s32, s32, 4096
buffer_load_dwordx4 v[36:39], v3, s[12:15], s32 offen nt
s_add_u32 s32, s32, 4096
s_waitcnt vmcnt(0)
buffer_load_dwordx4 v[40:43], v3, s[12:15], s32 offen nt
s_add_u32 s32, s32, 4096
buffer_load_dwordx4 v[44:47], v3, s[12:15], s32 offen nt
s_add_u32 s32, s32, 4096
s_waitcnt vmcnt(0)
buffer_load_dwordx4 v[48:51], v3, s[12:15], s32 offen nt
s_add_u32 s32, s32, 4096
buffer_load_dwordx4 v[52:55], v3, s[12:15], s32 offen nt
s_add_u32 s32, s32, 4096
s_waitcnt vmcnt(0)
buffer_load_dwordx4 v[56:59], v3, s[12:15], s32 offen nt
s_add_u32 s32, s32, 4096
buffer_load_dwordx4 v[60:63], v3, s[12:15], s32 offen nt
s_add_u32 s32, s32, 4096
s_waitcnt vmcnt(0)
s_waitcnt vmcnt(0)
ds_write_b128 v6, v[32:35] offset:0
ds_write_b128 v6, v[36:39] offset:1152
ds_write_b128 v6, v[40:43] offset:2304
ds_write_b128 v6, v[44:47] offset:3456
ds_write_b128 v6, v[48:51] offset:4608
ds_write_b128 v6, v[52:55] offset:5760
ds_write_b128 v6, v[56:59] offset:6912
ds_write_b128 v6, v[60:63] offset:8064
s_waitcnt lgkmcnt(0)
ds_read_b64_tr_b16 v[224:225], v7 offset:0
ds_read_b64_tr_b16 v[226:227], v7 offset:1152
ds_read_b64_tr_b16 v[228:229], v7 offset:32
ds_read_b64_tr_b16 v[230:231], v7 offset:1184
ds_read_b64_tr_b16 v[232:233], v7 offset:64
ds_read_b64_tr_b16 v[234:235], v7 offset:1216
ds_read_b64_tr_b16 v[236:237], v7 offset:96
ds_read_b64_tr_b16 v[238:239], v7 offset:1248
ds_read_b64_tr_b16 v[240:241], v7 offset:128
ds_read_b64_tr_b16 v[242:243], v7 offset:1280
ds_read_b64_tr_b16 v[244:245], v7 offset:160
ds_read_b64_tr_b16 v[246:247], v7 offset:1312
ds_read_b64_tr_b16 v[248:249], v7 offset:192
ds_read_b64_tr_b16 v[250:251], v7 offset:1344
ds_read_b64_tr_b16 v[252:253], v7 offset:224
ds_read_b64_tr_b16 v[254:255], v7 offset:1376
s_waitcnt lgkmcnt(0)
s_cmp_lg_u32 s34, 0
s_cbranch_scc1 L_nostat
v_and_b32 v14, 3, v2
v_lshlrev_b32 v14, 3, v14
s_mov_b32 s63, 262144
L_stspin:
s_sleep 8
ds_read_b64 v[32:33], v14 offset:4096
s_waitcnt lgkmcnt(0)
v_max_u32 v34, v32, v33
v_cmp_eq_u32 vcc, -1, v34
s_cbranch_vccz L_stok
s_sub_u32 s63, s63, 1
s_cbranch_scc0 L_stspin
L_stok:
v_max_f32_dpp v34, v32, v32 quad_perm:[1,0,3,2] row_mask:0xf bank_mask:0xf
s_nop 1
v_max_f32_dpp v34, v34, v34 quad_perm:[2,3,0,1] row_mask:0xf bank_mask:0xf
v_sub_f32 v35, v32, v34
v_mul_f32 v35, 0x3fb8aa3b, v35
v_exp_f32 v35, v35
s_nop 0
v_mul_f32 v35, v35, v33
s_nop 1
v_add_f32_dpp v35, v35, v35 quad_perm:[1,0,3,2] row_mask:0xf bank_mask:0xf
s_nop 1
v_add_f32_dpp v35, v35, v35 quad_perm:[2,3,0,1] row_mask:0xf bank_mask:0xf
v_mov_b32 v36, 0x7fc00000
v_cmp_eq_u32 vcc, -1, v34
s_nop 1
v_cndmask_b32 v34, v34, v36, vcc
v_cmp_eq_u32 vcc, -1, v35
s_nop 1
v_cndmask_b32 v35, v35, v36, vcc
v_mov_b32 v15, 0
s_lshl_b32 s58, s31, 7
s_add_u32 s58, s58, 622592
v_mov_b32 v52, v34
v_mov_b32 v53, v35
v_mov_b32 v54, s86
v_mov_b32 v55, s87
s_mov_b64 exec, 1
buffer_store_dwordx4 v[52:55], v15, s[16:19], s58 offen sc1
s_mov_b64 exec, -1
s_xor_b32 s59, s31, 1
s_lshl_b32 s59, s59, 7
s_add_u32 s59, s59, 622592
s_mov_b32 s63, 262144
L_prspin:
s_sleep 4
buffer_load_dwordx4 v[56:59], v15, s[16:19], s59 offen sc1
s_waitcnt vmcnt(0)
v_xor_b32 v58, s86, v58
v_xor_b32 v59, s87, v59
v_or_b32 v58, v58, v59
v_cmp_ne_u32 vcc, 0, v58
s_cbranch_vccz L_prok
s_sub_u32 s63, s63, 1
s_cbranch_scc0 L_prspin
L_prok:
v_mov_b32 v38, v56
v_mov_b32 v39, v57
v_max_f32 v40, v34, v38
v_sub_f32 v41, v34, v40
v_sub_f32 v42, v38, v40
v_sub_f32 v43, v32, v40
v_mul_f32 v41, 0x3fb8aa3b, v41
v_mul_f32 v42, 0x3fb8aa3b, v42
v_mul_f32 v43, 0x3fb8aa3b, v43
v_exp_f32 v41, v41
v_exp_f32 v42, v42
v_exp_f32 v43, v43
v_mul_f32 v41, v41, v35
v_fmac_f32 v41, v42, v39
v_rcp_f32 v41, v41
s_nop 0
v_mul_f32 v43, v43, v41
v_cmp_eq_u32 vcc, -1, v43
s_nop 1
v_cndmask_b32 v43, v43, v36, vcc
v_lshlrev_b32 v14, 2, v2
s_mov_b64 exec, 0xf
ds_write_b32 v14, v43 offset:4128
s_mov_b64 exec, -1
s_waitcnt lgkmcnt(0)
L_nostat:
v_and_b32 v14, 3, v2
v_lshlrev_b32 v14, 8, v14
v_lshlrev_b32 v15, 4, v4
v_add_u32 v14, v14, v15
v_bfe_u32 v14, v2, 2, 2
v_lshlrev_b32 v14, 8, v14
v_add_u32 v14, v14, v15
v_lshlrev_b32 v6, 13, v4
v_lshlrev_b32 v7, 3, v5
v_add_u32 v6, v6, v7
s_lshl_b32 s58, s29, 4
s_lshl_b32 s59, s34, 2
s_add_u32 s58, s58, s59
s_lshl_b32 s58, s58, 13
s_lshl_b32 s59, s62, 7
s_add_u32 s31, s58, s59
v_mov_b32 v7, 0x7fc00000
v_mov_b32 v64, 0
v_mov_b32 v65, 0
v_mov_b32 v66, 0
v_mov_b32 v67, 0
v_mov_b32 v68, 0
v_mov_b32 v69, 0
v_mov_b32 v70, 0
v_mov_b32 v71, 0
v_mov_b32 v72, 0
v_mov_b32 v73, 0
v_mov_b32 v74, 0
v_mov_b32 v75, 0
v_mov_b32 v76, 0
v_mov_b32 v77, 0
v_mov_b32 v78, 0
v_mov_b32 v79, 0
v_mov_b32 v80, 0
v_mov_b32 v81, 0
v_mov_b32 v82, 0
v_mov_b32 v83, 0
v_mov_b32 v84, 0
v_mov_b32 v85, 0
v_mov_b32 v86, 0
v_mov_b32 v87, 0
v_mov_b32 v88, 0
v_mov_b32 v89, 0
v_mov_b32 v90, 0
v_mov_b32 v91, 0
v_mov_b32 v92, 0
v_mov_b32 v93, 0
v_mov_b32 v94, 0
v_mov_b32 v95, 0
s_barrier
ds_read_b128 v[32:35], v14 offset:2048
ds_read_b128 v[36:39], v14 offset:2112
ds_read_b128 v[40:43], v14 offset:2176
ds_read_b128 v[44:47], v14 offset:2240
s_waitcnt lgkmcnt(3)
v_mfma_f32_16x16x32_bf16 v[64:67], v[32:35], v[128:131], v[64:67]
v_mfma_f32_16x16x32_bf16 v[68:71], v[32:35], v[132:135], v[68:71]
v_mfma_f32_16x16x32_bf16 v[72:75], v[32:35], v[136:139], v[72:75]
v_mfma_f32_16x16x32_bf16 v[76:79], v[32:35], v[140:143], v[76:79]
v_mfma_f32_16x16x32_bf16 v[80:83], v[32:35], v[144:147], v[80:83]
v_mfma_f32_16x16x32_bf16 v[84:87], v[32:35], v[148:151], v[84:87]
v_mfma_f32_16x16x32_bf16 v[88:91], v[32:35], v[152:155], v[88:91]
v_mfma_f32_16x16x32_bf16 v[92:95], v[32:35], v[156:159], v[92:95]
s_waitcnt lgkmcnt(2)
v_mfma_f32_16x16x32_bf16 v[64:67], v[36:39], v[160:163], v[64:67]
v_mfma_f32_16x16x32_bf16 v[68:71], v[36:39], v[164:167], v[68:71]
v_mfma_f32_16x16x32_bf16 v[72:75], v[36:39], v[168:171], v[72:75]
v_mfma_f32_16x16x32_bf16 v[76:79], v[36:39], v[172:175], v[76:79]
v_mfma_f32_16x16x32_bf16 v[80:83], v[36:39], v[176:179], v[80:83]
v_mfma_f32_16x16x32_bf16 v[84:87], v[36:39], v[180:183], v[84:87]
v_mfma_f32_16x16x32_bf16 v[88:91], v[36:39], v[184:187], v[88:91]
v_mfma_f32_16x16x32_bf16 v[92:95], v[36:39], v[188:191], v[92:95]
s_waitcnt lgkmcnt(1)
v_mfma_f32_16x16x32_bf16 v[64:67], v[40:43], v[192:195], v[64:67]
v_mfma_f32_16x16x32_bf16 v[68:71], v[40:43], v[196:199], v[68:71]
v_mfma_f32_16x16x32_bf16 v[72:75], v[40:43], v[200:203], v[72:75]
v_mfma_f32_16x16x32_bf16 v[76:79], v[40:43], v[204:207], v[76:79]
v_mfma_f32_16x16x32_bf16 v[80:83], v[40:43], v[208:211], v[80:83]
v_mfma_f32_16x16x32_bf16 v[84:87], v[40:43], v[212:215], v[84:87]
v_mfma_f32_16x16x32_bf16 v[88:91], v[40:43], v[216:219], v[88:91]
v_mfma_f32_16x16x32_bf16 v[92:95], v[40:43], v[220:223], v[92:95]
s_waitcnt lgkmcnt(0)
v_mfma_f32_16x16x32_bf16 v[64:67], v[44:47], v[224:227], v[64:67]
v_mfma_f32_16x16x32_bf16 v[68:71], v[44:47], v[228:231], v[68:71]
v_mfma_f32_16x16x32_bf16 v[72:75], v[44:47], v[232:235], v[72:75]
v_mfma_f32_16x16x32_bf16 v[76:79], v[44:47], v[236:239], v[76:79]
v_mfma_f32_16x16x32_bf16 v[80:83], v[44:47], v[240:243], v[80:83]
v_mfma_f32_16x16x32_bf16 v[84:87], v[44:47], v[244:247], v[84:87]
v_mfma_f32_16x16x32_bf16 v[88:91], v[44:47], v[248:251], v[88:91]
v_mfma_f32_16x16x32_bf16 v[92:95], v[44:47], v[252:255], v[92:95]
s_nop 4
v_permlane32_swap_b32 v64, v80
v_permlane32_swap_b32 v68, v84
v_permlane32_swap_b32 v72, v88
v_permlane32_swap_b32 v76, v92
v_add_f32 v64, v64, v80
v_add_f32 v68, v68, v84
v_add_f32 v72, v72, v88
v_add_f32 v76, v76, v92
s_nop 0
v_permlane16_swap_b32 v64, v72
v_permlane16_swap_b32 v68, v76
v_add_f32 v16, v64, v72
v_add_f32 v17, v68, v76
v_cmp_eq_u32 vcc, -1, v16
s_nop 1
v_cndmask_b32 v16, v16, v7, vcc
v_cmp_eq_u32 vcc, -1, v17
s_nop 1
v_cndmask_b32 v17, v17, v7, vcc
buffer_store_dwordx2 v[16:17], v6, s[16:19], s31 offen sc1
s_barrier
L_end:
s_endpgm
.section .rodata,"a"
.p2align 6
.amdhsa_kernel sequential_preLN__gqa_block_cached__dense_activation_relu__decode_kernel
.amdhsa_next_free_vgpr 256
.amdhsa_next_free_sgpr 96
.amdhsa_accum_offset 256
.amdhsa_group_segment_fixed_size 0
.amdhsa_kernarg_size 88
.amdhsa_user_sgpr_count 2
.amdhsa_user_sgpr_kernarg_segment_ptr 1
.amdhsa_system_sgpr_workgroup_id_x 1
.amdhsa_float_denorm_mode_32 3
.amdhsa_float_denorm_mode_16_64 3
.end_amdhsa_kernel
```
